```python
import torch

def _softmax(x, axis=-1):
    return torch.softmax(x, dim=axis)
def _gelu(x):
    return torch.nn.functional.gelu(x, approximate="tanh")
def _silu(x):
    return torch.nn.functional.silu(x)
def _sigmoid(x):
    return torch.sigmoid(x)
def _layernorm(x, axis=-1, eps=1e-5):
    m = x.mean(dim=axis, keepdim=True)
    v = x.var(dim=axis, keepdim=True, unbiased=False)
    return (x - m) / torch.sqrt(v + eps)
def _scatter_add(tgt, idx, src, axis=0):
    return tgt.clone().index_add_(axis, idx, src)
def _segment_sum(src, seg, n):
    out = torch.zeros((n,) + src.shape[1:], dtype=src.dtype)
    return out.index_add_(0, seg, src)
def _pad(x, pw):
    flat = tuple(v for pair in reversed(pw) for v in pair)
    return torch.nn.functional.pad(x, flat)

kernel_name = 'standalone__molecular_angular_gemnet__graph'

def setup_inputs():

    _w = (lambda a: (lambda t: t.to(torch.bfloat16) if t.is_floating_point() else t)(torch.as_tensor(a)))
    N, deg, De, L = 10000, 16, 4, 2
    E = N * deg
    T = E * deg
    NR = 8
    dist = torch.rand(E).to(float)
    angle = (torch.rand(T) * torch.pi).to(float)
    centers = torch.linspace(0.0, 1.0, NR).to(float)
    ang_freq = torch.arange(1, L + 1).to(float)
    return {
        "m": _w((lambda *s: torch.randn(*s, dtype=torch.bfloat16) * 0.05)(E, De)),
        "idx_in": _w((lambda lo, hi, *s: torch.randint(lo, hi, s))(0, E, T).to(torch.int64)),
        "idx_out": _w((lambda lo, hi, *s: torch.randint(lo, hi, s))(0, E, T).to(torch.int64)),
        "dist": _w(dist),
        "angle": _w(angle),
        "centers": _w(centers),
        "ang_freq": _w(ang_freq),
        "w_rbf": _w((lambda *s: torch.randn(*s, dtype=torch.bfloat16) * 0.4)(NR, De)),
        "w_sbf": _w((lambda *s: torch.randn(*s, dtype=torch.bfloat16) * 0.4)(NR * L, De)),
        "w_down": _w((lambda *s: torch.randn(*s, dtype=torch.bfloat16) * 0.4)(De, De)),
        "w_up": _w((lambda *s: torch.randn(*s, dtype=torch.bfloat16) * 0.4)(De, De)),
    }

def reference(m, idx_in, idx_out, dist, angle, centers, ang_freq, w_rbf, w_sbf, w_down, w_up):
    E, De = m.shape[0], m.shape[1]
    NR = centers.shape[0]
    L = ang_freq.shape[0]
    rbf = torch.exp(-10.0 * (dist[:, None] - centers[None, :]) ** 2)
    cbf = torch.cos(ang_freq[None, :] * angle[:, None])
    rbf_t = rbf[idx_out]
    sbf = torch.reshape(rbf_t[:, :, None] * cbf[:, None, :], (-1, NR * L))
    x = (m[idx_in] @ w_down) * (sbf @ w_sbf)
    agg = _segment_sum(x, idx_out, E)
    return m + (agg @ w_up) * (rbf @ w_rbf)
```

```asm
; @launch grid=(256,1,1) block=(1024,1,1) lds=148224
.amdgcn_target "amdgcn-amd-amdhsa--gfx950"
.text
.globl standalone__molecular_angular_gemnet__graph_kernel
.p2align 8
.type standalone__molecular_angular_gemnet__graph_kernel,@function
standalone__molecular_angular_gemnet__graph_kernel:
    s_cmpk_ge_u32 s2, 256
    s_cbranch_scc1 k2_end
    s_load_dwordx4 s[16:19], s[0:1], 8
    s_load_dwordx2 s[24:25], s[0:1], 32
    v_lshlrev_b32 v2, 2, v0
    v_mov_b32 v118, 0
    ds_write_b32 v2, v118 offset:6400
    s_movk_i32 s59, 1016
    s_mul_i32 s40, s2, 40640
    s_sub_u32 s40, s40, 163840
    s_cmp_lt_u32 s2, 16
    s_cbranch_scc1 k1_clr
k1_clrr:
    v_lshl_add_u32 v50, v0, 4, s40
    s_lshl_b32 s45, s59, 4
    v_add_u32 v51, s45, v50
    s_mul_i32 s45, s59, 32
    s_add_u32 s45, s45, s40
    v_lshl_add_u32 v52, v0, 3, s45
    v_lshrrev_b32 v55, 1, v50
    v_lshrrev_b32 v56, 1, v51
    v_lshrrev_b32 v57, 1, v52
    v_cmpx_gt_u32 vcc, s59, v0
    s_waitcnt lgkmcnt(0)
    global_load_dwordx4 v[4:7], v50, s[18:19] nt
    global_load_dwordx4 v[8:11], v51, s[18:19] nt
    global_load_dwordx2 v[12:13], v52, s[18:19] nt
    s_cmp_lt_u32 s2, 16
    s_cbranch_scc1 k1_sig
    s_barrier
k1_sigr:
    s_branch k1_h2
k1_clr:
    s_load_dwordx2 s[4:5], s[0:1], 104
    s_load_dwordx2 s[70:71], s[0:1], 96
    s_movk_i32 s59, 760
    s_mul_i32 s40, s2, 30400
    s_mul_i32 s45, s2, 16384
    s_add_u32 s45, s45, 13336576
    v_mov_b32 v106, 0
    v_mov_b32 v107, 0
    v_mov_b32 v108, 0
    v_mov_b32 v109, 0
    v_lshl_add_u32 v102, v0, 4, s45
    s_waitcnt lgkmcnt(0)
    global_store_dwordx4 v102, v[106:109], s[4:5] sc1
    s_branch k1_clrr
k1_sig:
    s_waitcnt vmcnt(3)
    s_barrier
    s_mov_b64 s[76:77], exec
    v_cmpx_eq_u32 vcc, 0, v0
    s_cbranch_execz k1_sig2
    s_lshl_b32 s45, s2, 2
    v_mov_b32 v102, s45
    v_mov_b32 v103, 1
    global_store_dword v102, v103, s[70:71] sc1
k1_sig2:
    s_mov_b64 exec, s[76:77]
    s_branch k1_sigr
k1_h2:
    s_mov_b64 s[76:77], exec
    s_load_dwordx2 s[4:5], s[0:1], 104
    s_load_dwordx2 s[8:9], s[0:1], 0
    s_load_dwordx2 s[12:13], s[0:1], 88
    s_load_dwordx8 s[60:67], s[0:1], 56
    s_load_dwordx2 s[68:69], s[0:1], 24
    s_load_dwordx2 s[70:71], s[0:1], 96
    s_mov_b64 exec, -1
    s_mov_b32 s6, 268435456
    s_mov_b32 s7, 0x20000
    s_mov_b32 s10, 1280000
    s_mov_b32 s11, 0x20000
    s_mov_b32 s14, 1280004
    s_mov_b32 s15, 0x20000
    v_lshrrev_b32 v3, 6, v0
    s_mov_b32 s78, s2
    v_readfirstlane_b32 s3, v3
    s_and_b32 s79, s2, 7
    s_lshl_b32 s79, s79, 5
    s_lshr_b32 s80, s2, 3
    s_add_u32 s79, s79, s80
    s_mul_i32 s2, s79, 5000
    s_and_b32 s82, s79, 31
    s_lshr_b32 s79, s79, 5
    s_lshl_b32 s79, s79, 13
    s_add_u32 s79, s79, s82
    s_lshl_b32 s79, s79, 2
    s_add_u32 s79, s79, 13336576
    s_mul_i32 s80, s80, 1
    s_mov_b32 s81, 400000
    s_mov_b64 exec, s[76:77]
    v_mov_b32 v3, 1
    v_mov_b32 v80, 0x49000000
    v_mov_b32 v81, 0x49000000
    s_mov_b32 s88, 0.15915494
    s_mov_b32 s89, 0.15915494
    s_mov_b32 s90, 0x4effc000
    s_mov_b32 s91, 0x4effc000
    s_mov_b32 s75, -640000
    s_mov_b32 s72, 6871948
    s_mov_b32 s73, -625
    s_mov_b32 s74, 0xfffff
    s_mul_i32 s50, s78, 41472
    s_lshr_b32 s51, s50, 2
    s_add_u32 s51, s51, 10682368
    s_add_u32 s50, s50, 55296
    s_cmp_lt_u32 s3, 10
    s_cselect_b32 s54, s51, s50
    s_add_u32 s51, s50, 16384
    s_add_u32 s52, s50, 32768
    s_add_u32 s53, s50, 49152
    s_mov_b64 exec, -1
    v_and_b32 v104, 63, v0
    v_mul_u32_u24 v104, 1028, v104
    v_subrev_u32 v102, s80, v0
    v_and_b32 v102, 255, v102
    v_lshlrev_b32 v102, 2, v102
    v_cmpx_gt_u32 vcc, 640, v0
    ds_write_b32 v2, v2 offset:1280
    ds_write_b32 v2, v2 offset:3840
    v_cmpx_gt_u32 vcc, 256, v0
    ds_write_b32 v2, v102 offset:0
    v_cmpx_gt_u32 vcc, 64, v0
    ds_write_b32 v104, v118 offset:7424
    s_mov_b64 exec, -1
    v_lshlrev_b32 v102, 4, v0
    v_add_u32 v102, 127744, v102
    v_mov_b32 v106, 0
    v_mov_b32 v107, 0
    v_mov_b32 v108, 0
    v_mov_b32 v109, 0
    ds_write_b128 v102, v[106:109] offset:0
    v_cmpx_gt_u32 vcc, 256, v0
    ds_write_b128 v102, v[106:109] offset:16384
    s_mov_b64 exec, s[76:77]
    s_waitcnt vmcnt(2)
    v_mul_hi_u32_u24 v30, s72, v4
    v_mad_i32_i24 v4, v30, s73, v4
    v_lshlrev_b32 v30, 2, v30
    ds_add_rtn_u32 v40, v30, v3 offset:6400
    v_mul_hi_u32_u24 v31, s72, v5
    v_mad_i32_i24 v5, v31, s73, v5
    v_lshlrev_b32 v31, 2, v31
    ds_add_rtn_u32 v41, v31, v3 offset:6400
    global_load_dwordx4 v[14:17], v50, s[16:17] nt
    global_load_dwordx2 v[24:25], v55, s[24:25] nt
    v_mul_hi_u32_u24 v32, s72, v6
    v_mad_i32_i24 v6, v32, s73, v6
    v_lshlrev_b32 v32, 2, v32
    ds_add_rtn_u32 v42, v32, v3 offset:6400
    v_mul_hi_u32_u24 v33, s72, v7
    v_mad_i32_i24 v7, v33, s73, v7
    v_lshlrev_b32 v33, 2, v33
    ds_add_rtn_u32 v43, v33, v3 offset:6400
    global_load_dwordx4 v[18:21], v51, s[16:17] nt
    global_load_dwordx2 v[26:27], v56, s[24:25] nt
    s_waitcnt vmcnt(5)
    v_mul_hi_u32_u24 v34, s72, v8
    v_mad_i32_i24 v8, v34, s73, v8
    v_lshlrev_b32 v34, 2, v34
    ds_add_rtn_u32 v44, v34, v3 offset:6400
    v_mul_hi_u32_u24 v35, s72, v9
    v_mad_i32_i24 v9, v35, s73, v9
    v_lshlrev_b32 v35, 2, v35
    ds_add_rtn_u32 v45, v35, v3 offset:6400
    v_mul_hi_u32_u24 v36, s72, v10
    v_mad_i32_i24 v10, v36, s73, v10
    v_lshlrev_b32 v36, 2, v36
    ds_add_rtn_u32 v46, v36, v3 offset:6400
    v_mul_hi_u32_u24 v37, s72, v11
    v_mad_i32_i24 v11, v37, s73, v11
    v_lshlrev_b32 v37, 2, v37
    ds_add_rtn_u32 v47, v37, v3 offset:6400
    global_load_dwordx2 v[22:23], v52, s[16:17] nt
    global_load_dword v28, v57, s[24:25] nt
    s_waitcnt vmcnt(6)
    v_mul_hi_u32_u24 v38, s72, v12
    v_mad_i32_i24 v12, v38, s73, v12
    v_lshlrev_b32 v38, 2, v38
    ds_add_rtn_u32 v48, v38, v3 offset:6400
    v_mul_hi_u32_u24 v39, s72, v13
    v_mad_i32_i24 v13, v39, s73, v13
    v_lshlrev_b32 v39, 2, v39
    ds_add_rtn_u32 v49, v39, v3 offset:6400
    s_waitcnt lgkmcnt(0)
    s_barrier
    s_cmp_lg_u32 s3, 0
    s_cbranch_scc1 k1_noscan
    v_lshlrev_b32 v72, 4, v0
    ds_read_b128 v[60:63], v72 offset:6400
    s_waitcnt lgkmcnt(0)
    v_add_u32 v65, v60, v61
    v_add_u32 v66, v65, v62
    v_add_u32 v67, v66, v63
    v_mov_b32 v64, v67
    v_subrev_u32 v67, 16384, v67
    s_nop 0
    v_add_u32_dpp v64, v64, v64 row_shr:1 row_mask:0xf bank_mask:0xf
    s_nop 1
    v_add_u32_dpp v64, v64, v64 row_shr:2 row_mask:0xf bank_mask:0xf
    s_nop 1
    v_add_u32_dpp v64, v64, v64 row_shr:4 row_mask:0xf bank_mask:0xf
    s_nop 1
    v_add_u32_dpp v64, v64, v64 row_shr:8 row_mask:0xf bank_mask:0xf
    s_nop 1
    v_add_u32_dpp v64, v64, v64 row_bcast:15 row_mask:0xa bank_mask:0xf
    s_nop 1
    v_add_u32_dpp v64, v64, v64 row_bcast:31 row_mask:0xc bank_mask:0xf
    v_sub_u32 v64, v64, v67
    v_add_u32 v67, v64, v66
    v_add_u32 v66, v64, v65
    v_add_u32 v65, v64, v60
    ds_write_b128 v72, v[64:67] offset:10512
    v_lshl_or_b32 v60, v60, 16, v64
    v_lshl_or_b32 v61, v61, 16, v65
    v_lshl_or_b32 v62, v62, 16, v66
    v_lshl_or_b32 v63, v63, 16, v67
    s_waitcnt lgkmcnt(0)
    s_barrier
    s_branch k1_scanned
k1_noscan:
    s_barrier
k1_scanned:
    ds_read_b32 v50, v30 offset:10512
    ds_read_b32 v51, v31 offset:10512
    ds_read_b32 v52, v32 offset:10512
    ds_read_b32 v53, v33 offset:10512
    ds_read_b32 v54, v34 offset:10512
    ds_read_b32 v55, v35 offset:10512
    ds_read_b32 v56, v36 offset:10512
    ds_read_b32 v57, v37 offset:10512
    ds_read_b32 v58, v38 offset:10512
    ds_read_b32 v59, v39 offset:10512
    s_mov_b64 exec, -1
    v_and_b32 v96, 3, v0
    v_lshrrev_b32 v97, 2, v0
    v_lshl_add_u32 v96, v96, 8, v97
    v_min_u32 v96, 624, v96
    v_lshlrev_b32 v96, 3, v96
    buffer_load_dwordx2 v[96:97], v96, s[8:11], s2 offen
    s_mov_b64 exec, s[76:77]
    s_mov_b64 exec, -1
    v_and_b32 v102, 3, v0
    v_lshrrev_b32 v103, 2, v0
    v_lshl_add_u32 v102, v102, 8, v103
    v_min_u32 v102, 624, v102
    s_lshr_b32 s0, s2, 2
    v_lshl_add_u32 v103, v102, 1, s0
    global_load_ushort v119, v103, s[68:69]
    s_mov_b64 exec, s[76:77]
    s_mov_b64 s[84:85], s[70:71]
    s_cmp_eq_u32 s3, 0
    s_cselect_b32 s86, 8, 0
    s_cmp_eq_u32 s3, 12
    s_cselect_b64 s[84:85], s[60:61], s[84:85]
    s_cselect_b32 s86, 8, s86
    s_cmp_eq_u32 s3, 13
    s_cselect_b64 s[84:85], s[62:63], s[84:85]
    s_cselect_b32 s86, 16, s86
    s_cmp_eq_u32 s3, 14
    s_cselect_b64 s[84:85], s[64:65], s[84:85]
    s_cselect_b32 s86, 4, s86
    s_cmp_eq_u32 s3, 15
    s_cselect_b64 s[84:85], s[66:67], s[84:85]
    s_cselect_b32 s86, 4, s86
    s_mov_b64 exec, -1
    v_and_b32 v78, 63, v0
    v_lshlrev_b32 v78, 3, v78
    s_bfm_b64 exec, s86, 0
    global_load_dwordx2 v[76:77], v78, s[84:85] sc1
    s_mov_b64 exec, s[76:77]
    s_waitcnt vmcnt(8)
    v_lshl_add_u32 v4, v14, 10, v4
    v_lshl_add_u32 v5, v15, 10, v5
    v_mul_hi_u32_u24 v14, s72, v14
    v_mul_hi_u32_u24 v15, s72, v15
    v_mad_i32_i24 v4, v14, s75, v4
    v_mad_i32_i24 v5, v15, s75, v5
    s_waitcnt vmcnt(7)
    v_lshlrev_b32 v74, 16, v24
    v_and_b32 v75, 0xffff0000, v24
    v_pk_mul_f32 v[74:75], v[74:75], s[88:89]
    v_fract_f32 v74, v74
    v_fract_f32 v75, v75
    v_cos_f32 v74, v74
    v_cos_f32 v75, v75
    s_nop 0
    v_pk_fma_f32 v[74:75], v[74:75], s[90:91], v[80:81]
    v_cvt_i32_f32 v74, v74
    v_cvt_i32_f32 v75, v75
    v_sub_u32 v74, v74, v4
    v_sub_u32 v75, v75, v5
    v_bfi_b32 v4, s74, v4, v74
    v_bfi_b32 v5, s74, v5, v75
    s_waitcnt lgkmcnt(9)
    v_add_u32 v40, v40, v50
    v_lshlrev_b32 v50, 2, v40
    ds_write_b8 v40, v14 offset:55808
    ds_write_b32 v50, v4 offset:16896
    s_waitcnt lgkmcnt(10)
    v_add_u32 v41, v41, v51
    v_lshlrev_b32 v51, 2, v41
    ds_write_b8 v41, v15 offset:55808
    ds_write_b32 v51, v5 offset:16896
    v_lshl_add_u32 v6, v16, 10, v6
    v_lshl_add_u32 v7, v17, 10, v7
    v_mul_hi_u32_u24 v16, s72, v16
    v_mul_hi_u32_u24 v17, s72, v17
    v_mad_i32_i24 v6, v16, s75, v6
    v_mad_i32_i24 v7, v17, s75, v7
    v_lshlrev_b32 v74, 16, v25
    v_and_b32 v75, 0xffff0000, v25
    v_pk_mul_f32 v[74:75], v[74:75], s[88:89]
    v_fract_f32 v74, v74
    v_fract_f32 v75, v75
    v_cos_f32 v74, v74
    v_cos_f32 v75, v75
    s_nop 0
    v_pk_fma_f32 v[74:75], v[74:75], s[90:91], v[80:81]
    v_cvt_i32_f32 v74, v74
    v_cvt_i32_f32 v75, v75
    v_sub_u32 v74, v74, v6
    v_sub_u32 v75, v75, v7
    v_bfi_b32 v6, s74, v6, v74
    v_bfi_b32 v7, s74, v7, v75
    s_waitcnt lgkmcnt(11)
    v_add_u32 v42, v42, v52
    v_lshlrev_b32 v52, 2, v42
    ds_write_b8 v42, v16 offset:55808
    ds_write_b32 v52, v6 offset:16896
    s_waitcnt lgkmcnt(12)
    v_add_u32 v43, v43, v53
    v_lshlrev_b32 v53, 2, v43
    ds_write_b8 v43, v17 offset:55808
    ds_write_b32 v53, v7 offset:16896
    s_waitcnt vmcnt(6)
    v_lshl_add_u32 v8, v18, 10, v8
    v_lshl_add_u32 v9, v19, 10, v9
    v_mul_hi_u32_u24 v18, s72, v18
    v_mul_hi_u32_u24 v19, s72, v19
    v_mad_i32_i24 v8, v18, s75, v8
    v_mad_i32_i24 v9, v19, s75, v9
    s_waitcnt vmcnt(5)
    v_lshlrev_b32 v74, 16, v26
    v_and_b32 v75, 0xffff0000, v26
    v_pk_mul_f32 v[74:75], v[74:75], s[88:89]
    v_fract_f32 v74, v74
    v_fract_f32 v75, v75
    v_cos_f32 v74, v74
    v_cos_f32 v75, v75
    s_nop 0
    v_pk_fma_f32 v[74:75], v[74:75], s[90:91], v[80:81]
    v_cvt_i32_f32 v74, v74
    v_cvt_i32_f32 v75, v75
    v_sub_u32 v74, v74, v8
    v_sub_u32 v75, v75, v9
    v_bfi_b32 v8, s74, v8, v74
    v_bfi_b32 v9, s74, v9, v75
    s_waitcnt lgkmcnt(13)
    v_add_u32 v44, v44, v54
    v_lshlrev_b32 v54, 2, v44
    ds_write_b8 v44, v18 offset:55808
    ds_write_b32 v54, v8 offset:16896
    s_waitcnt lgkmcnt(14)
    v_add_u32 v45, v45, v55
    v_lshlrev_b32 v55, 2, v45
    ds_write_b8 v45, v19 offset:55808
    ds_write_b32 v55, v9 offset:16896
    v_lshl_add_u32 v10, v20, 10, v10
    v_lshl_add_u32 v11, v21, 10, v11
    v_mul_hi_u32_u24 v20, s72, v20
    v_mul_hi_u32_u24 v21, s72, v21
    v_mad_i32_i24 v10, v20, s75, v10
    v_mad_i32_i24 v11, v21, s75, v11
    v_lshlrev_b32 v74, 16, v27
    v_and_b32 v75, 0xffff0000, v27
    v_pk_mul_f32 v[74:75], v[74:75], s[88:89]
    v_fract_f32 v74, v74
    v_fract_f32 v75, v75
    v_cos_f32 v74, v74
    v_cos_f32 v75, v75
    s_nop 0
    v_pk_fma_f32 v[74:75], v[74:75], s[90:91], v[80:81]
    v_cvt_i32_f32 v74, v74
    v_cvt_i32_f32 v75, v75
    v_sub_u32 v74, v74, v10
    v_sub_u32 v75, v75, v11
    v_bfi_b32 v10, s74, v10, v74
    v_bfi_b32 v11, s74, v11, v75
    s_waitcnt lgkmcnt(15)
    v_add_u32 v46, v46, v56
    v_lshlrev_b32 v56, 2, v46
    ds_write_b8 v46, v20 offset:55808
    ds_write_b32 v56, v10 offset:16896
    s_waitcnt lgkmcnt(15)
    v_add_u32 v47, v47, v57
    v_lshlrev_b32 v57, 2, v47
    ds_write_b8 v47, v21 offset:55808
    ds_write_b32 v57, v11 offset:16896
    s_waitcnt vmcnt(4)
    v_lshl_add_u32 v12, v22, 10, v12
    v_lshl_add_u32 v13, v23, 10, v13
    v_mul_hi_u32_u24 v22, s72, v22
    v_mul_hi_u32_u24 v23, s72, v23
    v_mad_i32_i24 v12, v22, s75, v12
    v_mad_i32_i24 v13, v23, s75, v13
    s_waitcnt vmcnt(3)
    v_lshlrev_b32 v74, 16, v28
    v_and_b32 v75, 0xffff0000, v28
    v_pk_mul_f32 v[74:75], v[74:75], s[88:89]
    v_fract_f32 v74, v74
    v_fract_f32 v75, v75
    v_cos_f32 v74, v74
    v_cos_f32 v75, v75
    s_nop 0
    v_pk_fma_f32 v[74:75], v[74:75], s[90:91], v[80:81]
    v_cvt_i32_f32 v74, v74
    v_cvt_i32_f32 v75, v75
    v_sub_u32 v74, v74, v12
    v_sub_u32 v75, v75, v13
    v_bfi_b32 v12, s74, v12, v74
    v_bfi_b32 v13, s74, v13, v75
    v_add_u32 v48, v48, v58
    v_lshlrev_b32 v58, 2, v48
    ds_write_b8 v48, v22 offset:55808
    ds_write_b32 v58, v12 offset:16896
    s_waitcnt lgkmcnt(15)
    v_add_u32 v49, v49, v59
    v_lshlrev_b32 v59, 2, v49
    ds_write_b8 v49, v23 offset:55808
    ds_write_b32 v59, v13 offset:16896
    s_waitcnt lgkmcnt(0)
    s_mov_b64 exec, -1
    v_lshlrev_b32 v1, 4, v0
    v_add_u32 v2, 72192, v1
    s_mul_i32 s55, s59, 5
    s_lshr_b32 s56, s55, 3
    s_lshr_b32 s55, s55, 1
    v_subrev_u32 v3, s56, v0
    s_sub_u32 s56, 640, s56
    s_barrier
    ds_read_b128 v[4:7], v2 offset:0
    ds_read_b128 v[8:11], v2 offset:16384
    ds_read_b128 v[12:15], v2 offset:32768
    ds_read_b128 v[16:19], v2 offset:49152
    v_cmpx_le_u32 vcc, s56, v3
    s_waitcnt lgkmcnt(3)
    buffer_store_dwordx4 v[4:7], v1, s[4:7], s54 offen sc1
    s_mov_b64 exec, -1
    s_sub_u32 s55, s55, 384
    v_cmpx_gt_i32 vcc, s55, v0
    s_cbranch_execz k1_skip
    s_waitcnt lgkmcnt(2)
    buffer_store_dwordx4 v[8:11], v1, s[4:7], s51 offen sc1
    s_sub_u32 s55, s55, 1024
    v_cmpx_gt_i32 vcc, s55, v0
    s_cbranch_execz k1_skip
    s_waitcnt lgkmcnt(1)
    buffer_store_dwordx4 v[12:15], v1, s[4:7], s52 offen sc1
    s_sub_u32 s55, s55, 1024
    v_cmpx_gt_i32 vcc, s55, v0
    s_cbranch_execz k1_skip
    s_waitcnt lgkmcnt(0)
    buffer_store_dwordx4 v[16:19], v1, s[4:7], s53 offen sc1
k1_skip:
    s_mov_b64 exec, -1
    s_waitcnt lgkmcnt(0)
    v_lshrrev_b32 v4, 6, v0
    v_and_b32 v5, 63, v0
    v_lshlrev_b32 v1, 2, v5
    v_add_u32 v2, 10665984, v5
    v_mov_b32 v3, 1028
    v_lshl_add_u32 v6, v4, 4, v5
    v_mul_u32_u24 v6, 41472, v6
    v_add_u32 v6, 0, v6
    v_lshl_add_u32 v7, v5, 4, v4
    v_add_u32 v7, s80, v7
    v_and_b32 v7, 255, v7
    v_mul_u32_u24 v5, 1028, v5
    v_lshl_add_u32 v4, v4, 2, v5
    s_lshl_b32 s0, s3, 11
    s_add_u32 s79, s79, s0
    v_lshlrev_b32 v24, 5, v1
    v_lshrrev_b32 v64, 5, v1
    v_and_b32 v65, 31, v1
    v_lshl_add_u32 v64, v64, 13, v65
    v_lshlrev_b32 v64, 2, v64
    s_lshl_b32 s0, s78, 7
    s_add_u32 s0, s0, 13336576
    s_waitcnt vmcnt(0)
    s_cmp_lt_u32 s3, 12
    s_cbranch_scc1 k2_now2
    s_lshl_b32 s87, s3, 3
    s_lshr_b32 s87, 0xe0c04000, s87
    s_and_b32 s87, s87, 0xff
    s_bfm_b64 exec, s86, 0
    v_add_u32 v78, s87, v78
    ds_write_b64 v78, v[76:77] offset:1024
k2_now2:
    s_mov_b64 exec, -1
    s_waitcnt lgkmcnt(0)
    s_cmp_lg_u32 s3, 0
    s_cbranch_scc1 k1_nofl
    s_bfm_b64 exec, s86, 0
k1_cchk:
    v_and_b32 v76, v76, v77
    v_cmp_ne_u32 vcc, 1, v76
    s_cbranch_vccnz k1_cwait
    s_mov_b64 exec, -1
    s_barrier
    buffer_store_dwordx4 v[60:63], v64, s[4:7], s0 offen sc1
    s_branch k1_fl
k1_nofl:
    s_barrier
k1_fl:
    s_cmp_ge_u32 s3, 8
    s_cbranch_scc1 k2_N
    s_mov_b64 exec, -1
    v_and_b32 v102, 12, v0
    v_lshlrev_b32 v103, 1, v102
    v_lshlrev_b32 v102, 2, v102
    ds_read_b64_tr_b16 v[72:73], v102 offset:1088
    ds_read_b64_tr_b16 v[74:75], v102 offset:1152
    ds_read_b64_tr_b16 v[76:77], v102 offset:1096
    ds_read_b64_tr_b16 v[78:79], v102 offset:1160
    ds_read_b64_tr_b16 v[80:81], v103 offset:1024
    ds_read_b64_tr_b16 v[82:83], v103 offset:1056
    v_lshlrev_b32 v119, 16, v119
    v_subrev_f32 v106, 0x0, v119
    v_subrev_f32 v107, 0x3e120000, v119
    v_subrev_f32 v108, 0x3e920000, v119
    v_subrev_f32 v109, 0x3edb0000, v119
    v_subrev_f32 v110, 0x3f120000, v119
    v_subrev_f32 v111, 0x3f370000, v119
    v_subrev_f32 v112, 0x3f5b0000, v119
    v_subrev_f32 v113, 0x3f800000, v119
    v_cvt_pk_bf16_f32 v107, v106, v107
    v_lshlrev_b32 v106, 16, v107
    v_and_b32 v107, 0xffff0000, v107
    v_cvt_pk_bf16_f32 v109, v108, v109
    v_lshlrev_b32 v108, 16, v109
    v_and_b32 v109, 0xffff0000, v109
    v_cvt_pk_bf16_f32 v111, v110, v111
    v_lshlrev_b32 v110, 16, v111
    v_and_b32 v111, 0xffff0000, v111
    v_cvt_pk_bf16_f32 v113, v112, v113
    v_lshlrev_b32 v112, 16, v113
    v_and_b32 v113, 0xffff0000, v113
    v_mul_f32 v106, v106, v106
    v_mul_f32 v107, v107, v107
    v_mul_f32 v108, v108, v108
    v_mul_f32 v109, v109, v109
    v_mul_f32 v110, v110, v110
    v_mul_f32 v111, v111, v111
    v_mul_f32 v112, v112, v112
    v_mul_f32 v113, v113, v113
    v_cvt_pk_bf16_f32 v107, v106, v107
    v_lshlrev_b32 v106, 16, v107
    v_and_b32 v107, 0xffff0000, v107
    v_cvt_pk_bf16_f32 v109, v108, v109
    v_lshlrev_b32 v108, 16, v109
    v_and_b32 v109, 0xffff0000, v109
    v_cvt_pk_bf16_f32 v111, v110, v111
    v_lshlrev_b32 v110, 16, v111
    v_and_b32 v111, 0xffff0000, v111
    v_cvt_pk_bf16_f32 v113, v112, v113
    v_lshlrev_b32 v112, 16, v113
    v_and_b32 v113, 0xffff0000, v113
    v_mul_f32 v106, 0xc1200000, v106
    v_mul_f32 v107, 0xc1200000, v107
    v_mul_f32 v108, 0xc1200000, v108
    v_mul_f32 v109, 0xc1200000, v109
    v_mul_f32 v110, 0xc1200000, v110
    v_mul_f32 v111, 0xc1200000, v111
    v_mul_f32 v112, 0xc1200000, v112
    v_mul_f32 v113, 0xc1200000, v113
    v_cvt_pk_bf16_f32 v107, v106, v107
    v_lshlrev_b32 v106, 16, v107
    v_and_b32 v107, 0xffff0000, v107
    v_cvt_pk_bf16_f32 v109, v108, v109
    v_lshlrev_b32 v108, 16, v109
    v_and_b32 v109, 0xffff0000, v109
    v_cvt_pk_bf16_f32 v111, v110, v111
    v_lshlrev_b32 v110, 16, v111
    v_and_b32 v111, 0xffff0000, v111
    v_cvt_pk_bf16_f32 v113, v112, v113
    v_lshlrev_b32 v112, 16, v113
    v_and_b32 v113, 0xffff0000, v113
    v_mul_f32 v106, 0x3fb8aa3b, v106
    v_mul_f32 v107, 0x3fb8aa3b, v107
    v_mul_f32 v108, 0x3fb8aa3b, v108
    v_mul_f32 v109, 0x3fb8aa3b, v109
    v_mul_f32 v110, 0x3fb8aa3b, v110
    v_mul_f32 v111, 0x3fb8aa3b, v111
    v_mul_f32 v112, 0x3fb8aa3b, v112
    v_mul_f32 v113, 0x3fb8aa3b, v113
    v_exp_f32 v106, v106
    v_exp_f32 v107, v107
    v_exp_f32 v108, v108
    v_exp_f32 v109, v109
    v_exp_f32 v110, v110
    v_exp_f32 v111, v111
    v_exp_f32 v112, v112
    v_exp_f32 v113, v113
    v_cvt_pk_bf16_f32 v102, v106, v107
    v_cvt_pk_bf16_f32 v103, v108, v109
    v_cvt_pk_bf16_f32 v104, v110, v111
    v_cvt_pk_bf16_f32 v105, v112, v113
    s_waitcnt lgkmcnt(0)
    v_mfma_f32_4x4x4_16b_bf16 v[84:87], v[102:103], v[72:73], 0
    v_mfma_f32_4x4x4_16b_bf16 v[88:91], v[102:103], v[76:77], 0
    v_mfma_f32_4x4x4_16b_bf16 v[92:95], v[102:103], v[80:81], 0
    v_mfma_f32_4x4x4_16b_bf16 v[84:87], v[104:105], v[74:75], v[84:87]
    v_mfma_f32_4x4x4_16b_bf16 v[88:91], v[104:105], v[78:79], v[88:91]
    v_mfma_f32_4x4x4_16b_bf16 v[92:95], v[104:105], v[82:83], v[92:95]
    v_lshrrev_b32 v106, 4, v0
    v_and_b32 v107, 3, v0
    v_lshl_add_u32 v106, v106, 2, v107
    v_bfe_u32 v107, v0, 2, 2
    v_mul_u32_u24 v107, 632, v107
    v_add_u32 v106, v106, v107
    v_lshlrev_b32 v5, 3, v106
    v_add_u32 v5, 46848, v5
    v_and_b32 v106, -2, v106
    v_lshlrev_b32 v119, 2, v106
    v_add_f32 v88, v88, v88
    v_add_f32 v89, v89, v89
    v_add_f32 v90, v90, v90
    v_cvt_pk_bf16_f32 v93, v92, v93
    v_lshlrev_b32 v92, 16, v93
    v_and_b32 v93, 0xffff0000, v93
    v_cvt_pk_bf16_f32 v94, v94, v94
    v_and_b32 v94, 0xffff0000, v94
    s_mov_b64 exec, -1
    v_and_b32 v108, 1, v0
    v_mul_u32_u24 v108, 0xffff, v108
    v_add_u32 v108, 1, v108
    v_mul_u32_u24 v108, 0x3f80, v108
    v_bfe_i32 v109, v0, 1, 1
    v_and_b32 v109, v109, v108
    v_xor_b32 v108, v109, v108
    v_mov_b32 v110, v96
    v_mov_b32 v111, v97
    s_nop 1
    v_mfma_f32_4x4x4_16b_bf16 v[96:99], v[110:111], v[108:109], 0
    s_mov_b64 exec, -1
    v_lshlrev_b32 v102, 4, v0
    v_add_u32 v102, 72192, v102
    v_mov_b32 v106, 0
    v_mov_b32 v107, 0
    v_mov_b32 v108, 0
    v_mov_b32 v109, 0
    ds_write_b128 v102, v[106:109] offset:0
    ds_write_b128 v102, v[106:109] offset:16384
    ds_write_b128 v102, v[106:109] offset:32768
    v_cmpx_gt_u32 vcc, 400, v0
    ds_write_b128 v102, v[106:109] offset:49152
    s_mov_b64 exec, 0xffff
    buffer_load_dword v101, v24, s[4:7], s79 offen sc1
    s_mov_b64 exec, 0xffff
    s_waitcnt vmcnt(0)
    v_cmp_eq_u32 vcc, 0, v101
    s_cbranch_vccnz k2_pwaitR
k2_pokR:
    v_and_b32 v100, 0xffff, v101
    v_lshrrev_b32 v101, 16, v101
    v_lshl_add_u32 v100, v100, 2, v6
    v_min_u32 v102, 63, v101
    v_readlane_b32 s36, v100, 0
    v_readlane_b32 s20, v102, 0
    v_readlane_b32 s37, v100, 1
    v_readlane_b32 s21, v102, 1
    v_readlane_b32 s38, v100, 2
    v_readlane_b32 s22, v102, 2
    v_readlane_b32 s39, v100, 3
    v_readlane_b32 s23, v102, 3
    v_readlane_b32 s40, v100, 4
    v_readlane_b32 s24, v102, 4
    v_readlane_b32 s41, v100, 5
    v_readlane_b32 s25, v102, 5
    v_readlane_b32 s42, v100, 6
    v_readlane_b32 s26, v102, 6
    v_readlane_b32 s43, v100, 7
    v_readlane_b32 s27, v102, 7
    v_readlane_b32 s44, v100, 8
    v_readlane_b32 s28, v102, 8
    v_readlane_b32 s45, v100, 9
    v_readlane_b32 s29, v102, 9
    v_readlane_b32 s46, v100, 10
    v_readlane_b32 s30, v102, 10
    v_readlane_b32 s47, v100, 11
    v_readlane_b32 s31, v102, 11
    v_readlane_b32 s48, v100, 12
    v_readlane_b32 s32, v102, 12
    v_readlane_b32 s49, v100, 13
    v_readlane_b32 s33, v102, 13
    v_readlane_b32 s50, v100, 14
    v_readlane_b32 s34, v102, 14
    v_readlane_b32 s51, v100, 15
    v_readlane_b32 s35, v102, 15
    s_bfm_b64 exec, s20, 0
    s_lshr_b32 vcc_lo, s36, 2
    buffer_load_ubyte v11, v2, s[4:7], vcc_lo offen sc1
    buffer_load_dword v10, v1, s[4:7], s36 offen sc1
    s_bfm_b64 exec, s21, 0
    s_lshr_b32 vcc_hi, s37, 2
    buffer_load_ubyte v15, v2, s[4:7], vcc_hi offen sc1
    buffer_load_dword v14, v1, s[4:7], s37 offen sc1
    s_bfm_b64 exec, s22, 0
    s_lshr_b32 vcc_lo, s38, 2
    buffer_load_ubyte v19, v2, s[4:7], vcc_lo offen sc1
    buffer_load_dword v18, v1, s[4:7], s38 offen sc1
    s_bfm_b64 exec, s23, 0
    s_lshr_b32 vcc_hi, s39, 2
    buffer_load_ubyte v23, v2, s[4:7], vcc_hi offen sc1
    buffer_load_dword v22, v1, s[4:7], s39 offen sc1
    s_bfm_b64 exec, s24, 0
    s_lshr_b32 vcc_lo, s40, 2
    buffer_load_ubyte v27, v2, s[4:7], vcc_lo offen sc1
    buffer_load_dword v26, v1, s[4:7], s40 offen sc1
    s_bfm_b64 exec, s25, 0
    s_lshr_b32 vcc_hi, s41, 2
    buffer_load_ubyte v31, v2, s[4:7], vcc_hi offen sc1
    buffer_load_dword v30, v1, s[4:7], s41 offen sc1
    s_bfm_b64 exec, s26, 0
    s_lshr_b32 vcc_lo, s42, 2
    buffer_load_ubyte v35, v2, s[4:7], vcc_lo offen sc1
    buffer_load_dword v34, v1, s[4:7], s42 offen sc1
    s_bfm_b64 exec, s27, 0
    s_lshr_b32 vcc_hi, s43, 2
    buffer_load_ubyte v39, v2, s[4:7], vcc_hi offen sc1
    buffer_load_dword v38, v1, s[4:7], s43 offen sc1
    s_bfm_b64 exec, s28, 0
    s_lshr_b32 vcc_lo, s44, 2
    buffer_load_ubyte v43, v2, s[4:7], vcc_lo offen sc1
    buffer_load_dword v42, v1, s[4:7], s44 offen sc1
    s_bfm_b64 exec, s29, 0
    s_lshr_b32 vcc_hi, s45, 2
    buffer_load_ubyte v47, v2, s[4:7], vcc_hi offen sc1
    buffer_load_dword v46, v1, s[4:7], s45 offen sc1
    s_bfm_b64 exec, s30, 0
    s_lshr_b32 vcc_lo, s46, 2
    buffer_load_ubyte v51, v2, s[4:7], vcc_lo offen sc1
    buffer_load_dword v50, v1, s[4:7], s46 offen sc1
    s_bfm_b64 exec, s31, 0
    s_lshr_b32 vcc_hi, s47, 2
    buffer_load_ubyte v55, v2, s[4:7], vcc_hi offen sc1
    buffer_load_dword v54, v1, s[4:7], s47 offen sc1
    s_bfm_b64 exec, s32, 0
    s_lshr_b32 vcc_lo, s48, 2
    buffer_load_ubyte v59, v2, s[4:7], vcc_lo offen sc1
    buffer_load_dword v58, v1, s[4:7], s48 offen sc1
    s_bfm_b64 exec, s33, 0
    s_lshr_b32 vcc_hi, s49, 2
    buffer_load_ubyte v63, v2, s[4:7], vcc_hi offen sc1
    buffer_load_dword v62, v1, s[4:7], s49 offen sc1
    s_bfm_b64 exec, s34, 0
    s_lshr_b32 vcc_lo, s50, 2
    buffer_load_ubyte v67, v2, s[4:7], vcc_lo offen sc1
    buffer_load_dword v66, v1, s[4:7], s50 offen sc1
    s_bfm_b64 exec, s35, 0
    s_lshr_b32 vcc_hi, s51, 2
    buffer_load_ubyte v71, v2, s[4:7], vcc_hi offen sc1
    buffer_load_dword v70, v1, s[4:7], s51 offen sc1
    s_mov_b64 exec, 0xffff
    v_cmp_lt_u32 vcc, 63, v101
    s_cbranch_vccnz k2_leftR
k2_leftrR:
    s_bfm_b64 exec, s20, 0
    s_waitcnt vmcnt(31)
    v_lshlrev_b32 v11, 2, v11
    ds_add_rtn_u32 v8, v11, v3 offset:0
    s_bfm_b64 exec, s21, 0
    s_waitcnt vmcnt(29)
    v_lshlrev_b32 v15, 2, v15
    ds_add_rtn_u32 v12, v15, v3 offset:0
    s_bfm_b64 exec, s22, 0
    s_waitcnt vmcnt(27)
    v_lshlrev_b32 v19, 2, v19
    ds_add_rtn_u32 v16, v19, v3 offset:0
    s_bfm_b64 exec, s20, 0
    s_waitcnt lgkmcnt(2)
    v_cmp_le_u32 vcc, 64764, v8
    s_cbranch_vccnz k2_soR0
k2_sorR0:
    ds_write_b32 v8, v10 offset:6400
    s_bfm_b64 exec, s23, 0
    s_waitcnt vmcnt(25)
    v_lshlrev_b32 v23, 2, v23
    ds_add_rtn_u32 v20, v23, v3 offset:0
    s_bfm_b64 exec, s21, 0
    s_waitcnt lgkmcnt(3)
    v_cmp_le_u32 vcc, 64764, v12
    s_cbranch_vccnz k2_soR1
k2_sorR1:
    ds_write_b32 v12, v14 offset:6400
    s_bfm_b64 exec, s24, 0
    s_waitcnt vmcnt(23)
    v_lshlrev_b32 v27, 2, v27
    ds_add_rtn_u32 v24, v27, v3 offset:0
    s_bfm_b64 exec, s22, 0
    s_waitcnt lgkmcnt(4)
    v_cmp_le_u32 vcc, 64764, v16
    s_cbranch_vccnz k2_soR2
k2_sorR2:
    ds_write_b32 v16, v18 offset:6400
    s_bfm_b64 exec, s25, 0
    s_waitcnt vmcnt(21)
    v_lshlrev_b32 v31, 2, v31
    ds_add_rtn_u32 v28, v31, v3 offset:0
    s_bfm_b64 exec, s23, 0
    s_waitcnt lgkmcnt(4)
    v_cmp_le_u32 vcc, 64764, v20
    s_cbranch_vccnz k2_soR3
k2_sorR3:
    ds_write_b32 v20, v22 offset:6400
    s_bfm_b64 exec, s26, 0
    s_waitcnt vmcnt(19)
    v_lshlrev_b32 v35, 2, v35
    ds_add_rtn_u32 v32, v35, v3 offset:0
    s_bfm_b64 exec, s24, 0
    s_waitcnt lgkmcnt(4)
    v_cmp_le_u32 vcc, 64764, v24
    s_cbranch_vccnz k2_soR4
k2_sorR4:
    ds_write_b32 v24, v26 offset:6400
    s_bfm_b64 exec, s27, 0
    s_waitcnt vmcnt(17)
    v_lshlrev_b32 v39, 2, v39
    ds_add_rtn_u32 v36, v39, v3 offset:0
    s_bfm_b64 exec, s25, 0
    s_waitcnt lgkmcnt(4)
    v_cmp_le_u32 vcc, 64764, v28
    s_cbranch_vccnz k2_soR5
k2_sorR5:
    ds_write_b32 v28, v30 offset:6400
    s_bfm_b64 exec, s28, 0
    s_waitcnt vmcnt(15)
    v_lshlrev_b32 v43, 2, v43
    ds_add_rtn_u32 v40, v43, v3 offset:0
    s_bfm_b64 exec, s26, 0
    s_waitcnt lgkmcnt(4)
    v_cmp_le_u32 vcc, 64764, v32
    s_cbranch_vccnz k2_soR6
k2_sorR6:
    ds_write_b32 v32, v34 offset:6400
    s_bfm_b64 exec, s29, 0
    s_waitcnt vmcnt(13)
    v_lshlrev_b32 v47, 2, v47
    ds_add_rtn_u32 v44, v47, v3 offset:0
    s_bfm_b64 exec, s27, 0
    s_waitcnt lgkmcnt(4)
    v_cmp_le_u32 vcc, 64764, v36
    s_cbranch_vccnz k2_soR7
k2_sorR7:
    ds_write_b32 v36, v38 offset:6400
    s_bfm_b64 exec, s30, 0
    s_waitcnt vmcnt(11)
    v_lshlrev_b32 v51, 2, v51
    ds_add_rtn_u32 v48, v51, v3 offset:0
    s_bfm_b64 exec, s28, 0
    s_waitcnt lgkmcnt(4)
    v_cmp_le_u32 vcc, 64764, v40
    s_cbranch_vccnz k2_soR8
k2_sorR8:
    ds_write_b32 v40, v42 offset:6400
    s_bfm_b64 exec, s31, 0
    s_waitcnt vmcnt(9)
    v_lshlrev_b32 v55, 2, v55
    ds_add_rtn_u32 v52, v55, v3 offset:0
    s_bfm_b64 exec, s29, 0
    s_waitcnt lgkmcnt(4)
    v_cmp_le_u32 vcc, 64764, v44
    s_cbranch_vccnz k2_soR9
k2_sorR9:
    ds_write_b32 v44, v46 offset:6400
    s_bfm_b64 exec, s32, 0
    s_waitcnt vmcnt(7)
    v_lshlrev_b32 v59, 2, v59
    ds_add_rtn_u32 v56, v59, v3 offset:0
    s_bfm_b64 exec, s30, 0
    s_waitcnt lgkmcnt(4)
    v_cmp_le_u32 vcc, 64764, v48
    s_cbranch_vccnz k2_soR10
k2_sorR10:
    ds_write_b32 v48, v50 offset:6400
    s_bfm_b64 exec, s33, 0
    s_waitcnt vmcnt(5)
    v_lshlrev_b32 v63, 2, v63
    ds_add_rtn_u32 v60, v63, v3 offset:0
    s_bfm_b64 exec, s31, 0
    s_waitcnt lgkmcnt(4)
    v_cmp_le_u32 vcc, 64764, v52
    s_cbranch_vccnz k2_soR11
k2_sorR11:
    ds_write_b32 v52, v54 offset:6400
    s_bfm_b64 exec, s34, 0
    s_waitcnt vmcnt(3)
    v_lshlrev_b32 v67, 2, v67
    ds_add_rtn_u32 v64, v67, v3 offset:0
    s_bfm_b64 exec, s32, 0
    s_waitcnt lgkmcnt(4)
    v_cmp_le_u32 vcc, 64764, v56
    s_cbranch_vccnz k2_soR12
k2_sorR12:
    ds_write_b32 v56, v58 offset:6400
    s_bfm_b64 exec, s35, 0
    s_waitcnt vmcnt(1)
    v_lshlrev_b32 v71, 2, v71
    ds_add_rtn_u32 v68, v71, v3 offset:0
    s_bfm_b64 exec, s33, 0
    s_waitcnt lgkmcnt(4)
    v_cmp_le_u32 vcc, 64764, v60
    s_cbranch_vccnz k2_soR13
k2_sorR13:
    ds_write_b32 v60, v62 offset:6400
    s_bfm_b64 exec, s34, 0
    s_waitcnt lgkmcnt(3)
    v_cmp_le_u32 vcc, 64764, v64
    s_cbranch_vccnz k2_soR14
k2_sorR14:
    ds_write_b32 v64, v66 offset:6400
    s_bfm_b64 exec, s35, 0
    s_waitcnt vmcnt(0) lgkmcnt(2)
    v_cmp_le_u32 vcc, 64764, v68
    s_cbranch_vccnz k2_soR15
k2_sorR15:
    ds_write_b32 v68, v70 offset:6400
    s_waitcnt lgkmcnt(0)
    s_barrier
    s_mov_b64 exec, 0xffff
    v_lshlrev_b32 v103, 2, v7
    ds_read_b32 v102, v103 offset:0
    s_mov_b64 exec, -1
    ds_wrxchg_rtn_b32 v10, v4, v118 offset:6400
    ds_wrxchg_rtn_b32 v14, v4, v118 offset:6464
    ds_wrxchg_rtn_b32 v18, v4, v118 offset:6528
    ds_wrxchg_rtn_b32 v22, v4, v118 offset:6592
    ds_wrxchg_rtn_b32 v26, v4, v118 offset:6656
    ds_wrxchg_rtn_b32 v30, v4, v118 offset:6720
    ds_wrxchg_rtn_b32 v34, v4, v118 offset:6784
    ds_wrxchg_rtn_b32 v38, v4, v118 offset:6848
    v_mul_u32_u24 v7, 5000, v7
    v_mov_b32 v3, 2528
    v_mov_b32 v1, 0x1ff8
    v_mov_b32 v2, 0xffc
    v_readlane_b32 s36, v7, 0
    v_readlane_b32 s37, v7, 1
    v_readlane_b32 s38, v7, 2
    v_readlane_b32 s39, v7, 3
    v_readlane_b32 s40, v7, 4
    v_readlane_b32 s41, v7, 5
    v_readlane_b32 s42, v7, 6
    v_readlane_b32 s43, v7, 7
    v_readlane_b32 s44, v7, 8
    v_readlane_b32 s45, v7, 9
    v_readlane_b32 s46, v7, 10
    v_readlane_b32 s47, v7, 11
    v_readlane_b32 s48, v7, 12
    v_readlane_b32 s49, v7, 13
    v_readlane_b32 s50, v7, 14
    v_readlane_b32 s51, v7, 15
    s_waitcnt lgkmcnt(8)
    v_min_u32 v102, 64764, v102
    v_mul_hi_u32_u24 v102, 4177985, v102
    ds_wrxchg_rtn_b32 v42, v4, v118 offset:6912
    ds_wrxchg_rtn_b32 v46, v4, v118 offset:6976
    ds_wrxchg_rtn_b32 v50, v4, v118 offset:7040
    ds_wrxchg_rtn_b32 v54, v4, v118 offset:7104
    ds_wrxchg_rtn_b32 v58, v4, v118 offset:7168
    ds_wrxchg_rtn_b32 v62, v4, v118 offset:7232
    ds_wrxchg_rtn_b32 v66, v4, v118 offset:7296
    ds_wrxchg_rtn_b32 v70, v4, v118 offset:7360
    v_readlane_b32 s20, v102, 0
    v_readlane_b32 s21, v102, 1
    v_readlane_b32 s22, v102, 2
    v_readlane_b32 s23, v102, 3
    v_readlane_b32 s24, v102, 4
    v_readlane_b32 s25, v102, 5
    v_readlane_b32 s26, v102, 6
    v_readlane_b32 s27, v102, 7
    v_readlane_b32 s28, v102, 8
    v_readlane_b32 s29, v102, 9
    v_readlane_b32 s30, v102, 10
    v_readlane_b32 s31, v102, 11
    v_readlane_b32 s32, v102, 12
    v_readlane_b32 s33, v102, 13
    v_readlane_b32 s34, v102, 14
    v_readlane_b32 s35, v102, 15
    s_bfm_b64 exec, s20, 0
    s_waitcnt lgkmcnt(15)
    v_lshrrev_b32 v102, 7, v10
    v_and_b32 v102, v1, v102
    buffer_load_dwordx2 v[8:9], v102, s[8:11], s36 offen
    v_lshlrev_b32 v103, 2, v10
    v_and_b32 v103, v2, v103
    ds_add_rtn_u32 v11, v103, v3 offset:1280
    v_cvt_f32_i32 v10, v10
    v_mul_f32 v10, 0x30002008, v10
    v_fma_f32 v104, v10, v10, -0.5
    v_cvt_pk_bf16_f32 v10, v10, v104
    s_bfm_b64 exec, s21, 0
    s_waitcnt lgkmcnt(15)
    v_lshrrev_b32 v102, 7, v14
    v_and_b32 v102, v1, v102
    buffer_load_dwordx2 v[12:13], v102, s[8:11], s37 offen
    v_lshlrev_b32 v103, 2, v14
    v_and_b32 v103, v2, v103
    ds_add_rtn_u32 v15, v103, v3 offset:1280
    v_cvt_f32_i32 v14, v14
    v_mul_f32 v14, 0x30002008, v14
    v_fma_f32 v104, v14, v14, -0.5
    v_cvt_pk_bf16_f32 v14, v14, v104
    s_bfm_b64 exec, s22, 0
    s_waitcnt lgkmcnt(15)
    v_lshrrev_b32 v102, 7, v18
    v_and_b32 v102, v1, v102
    buffer_load_dwordx2 v[16:17], v102, s[8:11], s38 offen
    v_lshlrev_b32 v103, 2, v18
    v_and_b32 v103, v2, v103
    ds_add_rtn_u32 v19, v103, v3 offset:1280
    v_cvt_f32_i32 v18, v18
    v_mul_f32 v18, 0x30002008, v18
    v_fma_f32 v104, v18, v18, -0.5
    v_cvt_pk_bf16_f32 v18, v18, v104
    s_bfm_b64 exec, s23, 0
    s_waitcnt lgkmcnt(15)
    v_lshrrev_b32 v102, 7, v22
    v_and_b32 v102, v1, v102
    buffer_load_dwordx2 v[20:21], v102, s[8:11], s39 offen
    v_lshlrev_b32 v103, 2, v22
    v_and_b32 v103, v2, v103
    ds_add_rtn_u32 v23, v103, v3 offset:1280
    v_cvt_f32_i32 v22, v22
    v_mul_f32 v22, 0x30002008, v22
    v_fma_f32 v104, v22, v22, -0.5
    v_cvt_pk_bf16_f32 v22, v22, v104
    s_waitcnt lgkmcnt(0)
    s_barrier
    s_bfm_b64 exec, s20, 0
    s_waitcnt vmcnt(3)
    v_cmp_le_u32 vcc, 40448, v11
    v_lshlrev_b32 v108, 1, v11
    s_cbranch_vccnz k2_ovR0
k2_ovrR0:
    ds_write_b32 v11, v10 offset:6400
    ds_write_b64 v108, v[8:9] offset:46848
    s_bfm_b64 exec, s24, 0
    v_lshrrev_b32 v102, 7, v26
    v_and_b32 v102, v1, v102
    buffer_load_dwordx2 v[24:25], v102, s[8:11], s40 offen
    v_lshlrev_b32 v103, 2, v26
    v_and_b32 v103, v2, v103
    ds_add_rtn_u32 v27, v103, v3 offset:1280
    v_cvt_f32_i32 v26, v26
    v_mul_f32 v26, 0x30002008, v26
    v_fma_f32 v104, v26, v26, -0.5
    v_cvt_pk_bf16_f32 v26, v26, v104
    s_bfm_b64 exec, s21, 0
    s_waitcnt vmcnt(3)
    v_cmp_le_u32 vcc, 40448, v15
    v_lshlrev_b32 v108, 1, v15
    s_cbranch_vccnz k2_ovR1
k2_ovrR1:
    ds_write_b32 v15, v14 offset:6400
    ds_write_b64 v108, v[12:13] offset:46848
    s_bfm_b64 exec, s25, 0
    v_lshrrev_b32 v102, 7, v30
    v_and_b32 v102, v1, v102
    buffer_load_dwordx2 v[28:29], v102, s[8:11], s41 offen
    v_lshlrev_b32 v103, 2, v30
    v_and_b32 v103, v2, v103
    ds_add_rtn_u32 v31, v103, v3 offset:1280
    v_cvt_f32_i32 v30, v30
    v_mul_f32 v30, 0x30002008, v30
    v_fma_f32 v104, v30, v30, -0.5
    v_cvt_pk_bf16_f32 v30, v30, v104
    s_bfm_b64 exec, s22, 0
    s_waitcnt vmcnt(3)
    v_cmp_le_u32 vcc, 40448, v19
    v_lshlrev_b32 v108, 1, v19
    s_cbranch_vccnz k2_ovR2
k2_ovrR2:
    ds_write_b32 v19, v18 offset:6400
    ds_write_b64 v108, v[16:17] offset:46848
    s_bfm_b64 exec, s26, 0
    v_lshrrev_b32 v102, 7, v34
    v_and_b32 v102, v1, v102
    buffer_load_dwordx2 v[32:33], v102, s[8:11], s42 offen
    v_lshlrev_b32 v103, 2, v34
    v_and_b32 v103, v2, v103
    ds_add_rtn_u32 v35, v103, v3 offset:1280
    v_cvt_f32_i32 v34, v34
    v_mul_f32 v34, 0x30002008, v34
    v_fma_f32 v104, v34, v34, -0.5
    v_cvt_pk_bf16_f32 v34, v34, v104
    s_bfm_b64 exec, s23, 0
    s_waitcnt vmcnt(3)
    v_cmp_le_u32 vcc, 40448, v23
    v_lshlrev_b32 v108, 1, v23
    s_cbranch_vccnz k2_ovR3
k2_ovrR3:
    ds_write_b32 v23, v22 offset:6400
    ds_write_b64 v108, v[20:21] offset:46848
    s_bfm_b64 exec, s27, 0
    v_lshrrev_b32 v102, 7, v38
    v_and_b32 v102, v1, v102
    buffer_load_dwordx2 v[36:37], v102, s[8:11], s43 offen
    v_lshlrev_b32 v103, 2, v38
    v_and_b32 v103, v2, v103
    ds_add_rtn_u32 v39, v103, v3 offset:1280
    v_cvt_f32_i32 v38, v38
    v_mul_f32 v38, 0x30002008, v38
    v_fma_f32 v104, v38, v38, -0.5
    v_cvt_pk_bf16_f32 v38, v38, v104
    s_barrier
    s_bfm_b64 exec, s28, 0
    v_lshrrev_b32 v102, 7, v42
    v_and_b32 v102, v1, v102
    buffer_load_dwordx2 v[40:41], v102, s[8:11], s44 offen
    v_lshlrev_b32 v103, 2, v42
    v_and_b32 v103, v2, v103
    ds_add_rtn_u32 v43, v103, v3 offset:3840
    v_cvt_f32_i32 v42, v42
    v_mul_f32 v42, 0x30002008, v42
    v_fma_f32 v104, v42, v42, -0.5
    v_cvt_pk_bf16_f32 v42, v42, v104
    s_bfm_b64 exec, s29, 0
    v_lshrrev_b32 v102, 7, v46
    v_and_b32 v102, v1, v102
    buffer_load_dwordx2 v[44:45], v102, s[8:11], s45 offen
    v_lshlrev_b32 v103, 2, v46
    v_and_b32 v103, v2, v103
    ds_add_rtn_u32 v47, v103, v3 offset:3840
    v_cvt_f32_i32 v46, v46
    v_mul_f32 v46, 0x30002008, v46
    v_fma_f32 v104, v46, v46, -0.5
    v_cvt_pk_bf16_f32 v46, v46, v104
    s_bfm_b64 exec, s24, 0
    s_waitcnt vmcnt(5) lgkmcnt(11)
    v_cmp_le_u32 vcc, 40448, v27
    v_lshlrev_b32 v108, 1, v27
    s_cbranch_vccnz k2_ovR4
k2_ovrR4:
    ds_write_b32 v27, v26 offset:6400
    ds_write_b64 v108, v[24:25] offset:46848
    s_bfm_b64 exec, s25, 0
    s_waitcnt vmcnt(4) lgkmcnt(10)
    v_cmp_le_u32 vcc, 40448, v31
    v_lshlrev_b32 v108, 1, v31
    s_cbranch_vccnz k2_ovR5
k2_ovrR5:
    ds_write_b32 v31, v30 offset:6400
    ds_write_b64 v108, v[28:29] offset:46848
    s_bfm_b64 exec, s26, 0
    s_waitcnt vmcnt(3) lgkmcnt(9)
    v_cmp_le_u32 vcc, 40448, v35
    v_lshlrev_b32 v108, 1, v35
    s_cbranch_vccnz k2_ovR6
k2_ovrR6:
    ds_write_b32 v35, v34 offset:6400
    ds_write_b64 v108, v[32:33] offset:46848
    s_bfm_b64 exec, s27, 0
    s_waitcnt vmcnt(2) lgkmcnt(8)
    v_cmp_le_u32 vcc, 40448, v39
    v_lshlrev_b32 v108, 1, v39
    s_cbranch_vccnz k2_ovR7
k2_ovrR7:
    ds_write_b32 v39, v38 offset:6400
    ds_write_b64 v108, v[36:37] offset:46848
    s_waitcnt lgkmcnt(0)
    s_barrier
    s_bfm_b64 exec, s30, 0
    v_lshrrev_b32 v102, 7, v50
    v_and_b32 v102, v1, v102
    buffer_load_dwordx2 v[48:49], v102, s[8:11], s46 offen
    v_lshlrev_b32 v103, 2, v50
    v_and_b32 v103, v2, v103
    ds_add_rtn_u32 v51, v103, v3 offset:3840
    v_cvt_f32_i32 v50, v50
    v_mul_f32 v50, 0x30002008, v50
    v_fma_f32 v104, v50, v50, -0.5
    v_cvt_pk_bf16_f32 v50, v50, v104
    s_mov_b64 exec, -1
    ds_read_b64_tr_b16 v[8:9], v119 offset:6400
    ds_read_b64_tr_b16 v[10:11], v5 offset:0
    ds_read_b64_tr_b16 v[12:13], v119 offset:7424
    ds_read_b64_tr_b16 v[14:15], v5 offset:2048
    ds_read_b64_tr_b16 v[16:17], v119 offset:8448
    ds_read_b64_tr_b16 v[18:19], v5 offset:4096
    ds_read_b64_tr_b16 v[20:21], v119 offset:16512
    ds_read_b64_tr_b16 v[22:23], v5 offset:20224
    ds_read_b64_tr_b16 v[24:25], v119 offset:17536
    ds_read_b64_tr_b16 v[26:27], v5 offset:22272
    ds_read_b64_tr_b16 v[28:29], v119 offset:18560
    ds_read_b64_tr_b16 v[30:31], v5 offset:24320
    ds_read_b64_tr_b16 v[32:33], v119 offset:26624
    ds_read_b64_tr_b16 v[34:35], v5 offset:40448
    v_lshrrev_b32 v102, 6, v0
    v_and_b32 v103, 3, v0
    v_lshl_add_u32 v102, v102, 2, v103
    v_bfe_u32 v103, v0, 2, 4
    v_mul_u32_u24 v103, 2528, v103
    v_min_u32 v104, 29, v102
    v_lshl_add_u32 v102, v102, 4, v103
    v_lshl_add_u32 v104, v104, 4, v103
    v_mov_b32 v106, 0
    v_mov_b32 v107, 0
    v_mov_b32 v108, 0
    v_mov_b32 v109, 0
    ds_read_b64_tr_b16 v[36:37], v119 offset:27648
    ds_read_b64_tr_b16 v[38:39], v5 offset:42496
    s_waitcnt lgkmcnt(14)
    v_mfma_f32_4x4x4_16b_bf16 v[72:75], v[8:9], v[10:11], 0
    ds_read_b64_tr_b16 v[110:111], v119 offset:28672
    ds_read_b64_tr_b16 v[112:113], v5 offset:44544
    s_waitcnt lgkmcnt(14)
    v_mfma_f32_4x4x4_16b_bf16 v[76:79], v[12:13], v[14:15], 0
    ds_read_b64_tr_b16 v[114:115], v119 offset:36736
    ds_read_b64_tr_b16 v[116:117], v5 offset:60672
    s_waitcnt lgkmcnt(14)
    v_mfma_f32_4x4x4_16b_bf16 v[80:83], v[16:17], v[18:19], 0
    ds_read_b64_tr_b16 v[8:9], v119 offset:37760
    ds_read_b64_tr_b16 v[10:11], v5 offset:62720
    s_waitcnt lgkmcnt(14)
    v_mfma_f32_4x4x4_16b_bf16 v[72:75], v[20:21], v[22:23], v[72:75]
    ds_read_b64_tr_b16 v[12:13], v119 offset:38784
    ds_read_b64_tr_b16 v[14:15], v5 offset:64768
    ds_write_b128 v102, v[106:109] offset:6400
    ds_write_b128 v102, v[106:109] offset:7424
    ds_write_b128 v104, v[106:109] offset:8448
    s_waitcnt lgkmcnt(15)
    v_mfma_f32_4x4x4_16b_bf16 v[76:79], v[24:25], v[26:27], v[76:79]
    v_mfma_f32_4x4x4_16b_bf16 v[80:83], v[28:29], v[30:31], v[80:83]
    s_waitcnt lgkmcnt(13)
    v_mfma_f32_4x4x4_16b_bf16 v[72:75], v[32:33], v[34:35], v[72:75]
    s_waitcnt lgkmcnt(11)
    v_mfma_f32_4x4x4_16b_bf16 v[76:79], v[36:37], v[38:39], v[76:79]
    s_waitcnt lgkmcnt(9)
    v_mfma_f32_4x4x4_16b_bf16 v[80:83], v[110:111], v[112:113], v[80:83]
    s_waitcnt lgkmcnt(7)
    v_mfma_f32_4x4x4_16b_bf16 v[72:75], v[114:115], v[116:117], v[72:75]
    s_waitcnt lgkmcnt(5)
    v_mfma_f32_4x4x4_16b_bf16 v[76:79], v[8:9], v[10:11], v[76:79]
    s_waitcnt lgkmcnt(3)
    v_mfma_f32_4x4x4_16b_bf16 v[80:83], v[12:13], v[14:15], v[80:83]
    s_bfm_b64 exec, s31, 0
    v_lshrrev_b32 v102, 7, v54
    v_and_b32 v102, v1, v102
    buffer_load_dwordx2 v[52:53], v102, s[8:11], s47 offen
    v_lshlrev_b32 v103, 2, v54
    v_and_b32 v103, v2, v103
    ds_add_rtn_u32 v55, v103, v3 offset:3840
    v_cvt_f32_i32 v54, v54
    v_mul_f32 v54, 0x30002008, v54
    v_fma_f32 v104, v54, v54, -0.5
    v_cvt_pk_bf16_f32 v54, v54, v104
    s_waitcnt lgkmcnt(0)
    s_barrier
    s_bfm_b64 exec, s32, 0
    v_lshrrev_b32 v102, 7, v58
    v_and_b32 v102, v1, v102
    buffer_load_dwordx2 v[56:57], v102, s[8:11], s48 offen
    v_lshlrev_b32 v103, 2, v58
    v_and_b32 v103, v2, v103
    ds_add_rtn_u32 v59, v103, v3 offset:3840
    v_cvt_f32_i32 v58, v58
    v_mul_f32 v58, 0x30002008, v58
    v_fma_f32 v104, v58, v58, -0.5
    v_cvt_pk_bf16_f32 v58, v58, v104
    s_bfm_b64 exec, s28, 0
    s_waitcnt vmcnt(4)
    v_cmp_le_u32 vcc, 40448, v43
    v_lshlrev_b32 v108, 1, v43
    s_cbranch_vccnz k2_ovR8
k2_ovrR8:
    ds_write_b32 v43, v42 offset:6400
    ds_write_b64 v108, v[40:41] offset:46848
    s_bfm_b64 exec, s33, 0
    v_lshrrev_b32 v102, 7, v62
    v_and_b32 v102, v1, v102
    buffer_load_dwordx2 v[60:61], v102, s[8:11], s49 offen
    v_lshlrev_b32 v103, 2, v62
    v_and_b32 v103, v2, v103
    ds_add_rtn_u32 v63, v103, v3 offset:3840
    v_cvt_f32_i32 v62, v62
    v_mul_f32 v62, 0x30002008, v62
    v_fma_f32 v104, v62, v62, -0.5
    v_cvt_pk_bf16_f32 v62, v62, v104
    s_bfm_b64 exec, s29, 0
    s_waitcnt vmcnt(4)
    v_cmp_le_u32 vcc, 40448, v47
    v_lshlrev_b32 v108, 1, v47
    s_cbranch_vccnz k2_ovR9
k2_ovrR9:
    ds_write_b32 v47, v46 offset:6400
    ds_write_b64 v108, v[44:45] offset:46848
    s_bfm_b64 exec, s34, 0
    v_lshrrev_b32 v102, 7, v66
    v_and_b32 v102, v1, v102
    buffer_load_dwordx2 v[64:65], v102, s[8:11], s50 offen
    v_lshlrev_b32 v103, 2, v66
    v_and_b32 v103, v2, v103
    ds_add_rtn_u32 v67, v103, v3 offset:3840
    v_cvt_f32_i32 v66, v66
    v_mul_f32 v66, 0x30002008, v66
    v_fma_f32 v104, v66, v66, -0.5
    v_cvt_pk_bf16_f32 v66, v66, v104
    s_bfm_b64 exec, s30, 0
    s_waitcnt vmcnt(4)
    v_cmp_le_u32 vcc, 40448, v51
    v_lshlrev_b32 v108, 1, v51
    s_cbranch_vccnz k2_ovR10
k2_ovrR10:
    ds_write_b32 v51, v50 offset:6400
    ds_write_b64 v108, v[48:49] offset:46848
    s_bfm_b64 exec, s35, 0
    v_lshrrev_b32 v102, 7, v70
    v_and_b32 v102, v1, v102
    buffer_load_dwordx2 v[68:69], v102, s[8:11], s51 offen
    v_lshlrev_b32 v103, 2, v70
    v_and_b32 v103, v2, v103
    ds_add_rtn_u32 v71, v103, v3 offset:3840
    v_cvt_f32_i32 v70, v70
    v_mul_f32 v70, 0x30002008, v70
    v_fma_f32 v104, v70, v70, -0.5
    v_cvt_pk_bf16_f32 v70, v70, v104
    s_mov_b64 exec, -1
    v_and_b32 v102, 12, v0
    v_lshlrev_b32 v102, 1, v102
    ds_read_b64_tr_b16 v[10:11], v102 offset:1216
    ds_read_b64_tr_b16 v[14:15], v102 offset:1248
    v_lshlrev_b32 v100, 3, v0
    v_add_u32 v100, 127744, v100
    v_lshlrev_b32 v101, 1, v0
    s_add_u32 s18, s2, 4096
    s_mov_b32 s16, 0xf0f0f0f0
    s_mov_b32 s17, 0xf0f0f0f0
    s_waitcnt lgkmcnt(0)
    v_lshlrev_b32 v8, 16, v10
    v_and_b32 v9, 0xffff0000, v10
    v_lshlrev_b32 v10, 16, v11
    v_and_b32 v11, 0xffff0000, v11
    v_lshlrev_b32 v12, 16, v14
    v_and_b32 v13, 0xffff0000, v14
    v_lshlrev_b32 v14, 16, v15
    v_and_b32 v15, 0xffff0000, v15
    s_bfm_b64 exec, s31, 0
    s_waitcnt vmcnt(4)
    v_cmp_le_u32 vcc, 40448, v55
    v_lshlrev_b32 v108, 1, v55
    s_cbranch_vccnz k2_ovR11
k2_ovrR11:
    ds_write_b32 v55, v54 offset:6400
    ds_write_b64 v108, v[52:53] offset:46848
    s_bfm_b64 exec, s32, 0
    s_waitcnt vmcnt(3)
    v_cmp_le_u32 vcc, 40448, v59
    v_lshlrev_b32 v108, 1, v59
    s_cbranch_vccnz k2_ovR12
k2_ovrR12:
    ds_write_b32 v59, v58 offset:6400
    ds_write_b64 v108, v[56:57] offset:46848
    s_bfm_b64 exec, s33, 0
    s_waitcnt vmcnt(2)
    v_cmp_le_u32 vcc, 40448, v63
    v_lshlrev_b32 v108, 1, v63
    s_cbranch_vccnz k2_ovR13
k2_ovrR13:
    ds_write_b32 v63, v62 offset:6400
    ds_write_b64 v108, v[60:61] offset:46848
    s_bfm_b64 exec, s34, 0
    s_waitcnt vmcnt(1)
    v_cmp_le_u32 vcc, 40448, v67
    v_lshlrev_b32 v108, 1, v67
    s_cbranch_vccnz k2_ovR14
k2_ovrR14:
    ds_write_b32 v67, v66 offset:6400
    ds_write_b64 v108, v[64:65] offset:46848
    s_bfm_b64 exec, s35, 0
    s_waitcnt vmcnt(0)
    v_cmp_le_u32 vcc, 40448, v71
    v_lshlrev_b32 v108, 1, v71
    s_cbranch_vccnz k2_ovR15
k2_ovrR15:
    ds_write_b32 v71, v70 offset:6400
    ds_write_b64 v108, v[68:69] offset:46848
    s_waitcnt lgkmcnt(0)
    s_barrier
    s_mov_b64 exec, -1
    ds_read_b64_tr_b16 v[16:17], v119 offset:6400
    ds_read_b64_tr_b16 v[18:19], v5 offset:0
    ds_read_b64_tr_b16 v[20:21], v119 offset:7424
    ds_read_b64_tr_b16 v[22:23], v5 offset:2048
    ds_read_b64_tr_b16 v[24:25], v119 offset:8448
    ds_read_b64_tr_b16 v[26:27], v5 offset:4096
    ds_read_b64_tr_b16 v[28:29], v119 offset:16512
    ds_read_b64_tr_b16 v[30:31], v5 offset:20224
    ds_read_b64_tr_b16 v[32:33], v119 offset:17536
    ds_read_b64_tr_b16 v[34:35], v5 offset:22272
    ds_read_b64_tr_b16 v[36:37], v119 offset:18560
    ds_read_b64_tr_b16 v[38:39], v5 offset:24320
    ds_read_b64_tr_b16 v[40:41], v119 offset:26624
    ds_read_b64_tr_b16 v[42:43], v5 offset:40448
    ds_read_b64_tr_b16 v[44:45], v119 offset:27648
    ds_read_b64_tr_b16 v[46:47], v5 offset:42496
    s_waitcnt lgkmcnt(14)
    v_mfma_f32_4x4x4_16b_bf16 v[72:75], v[16:17], v[18:19], v[72:75]
    ds_read_b64_tr_b16 v[48:49], v119 offset:28672
    ds_read_b64_tr_b16 v[50:51], v5 offset:44544
    s_waitcnt lgkmcnt(14)
    v_mfma_f32_4x4x4_16b_bf16 v[76:79], v[20:21], v[22:23], v[76:79]
    ds_read_b64_tr_b16 v[52:53], v119 offset:36736
    ds_read_b64_tr_b16 v[54:55], v5 offset:60672
    s_waitcnt lgkmcnt(14)
    v_mfma_f32_4x4x4_16b_bf16 v[80:83], v[24:25], v[26:27], v[80:83]
    ds_read_b64_tr_b16 v[56:57], v119 offset:37760
    ds_read_b64_tr_b16 v[58:59], v5 offset:62720
    s_waitcnt lgkmcnt(14)
    v_mfma_f32_4x4x4_16b_bf16 v[72:75], v[28:29], v[30:31], v[72:75]
    ds_read_b64_tr_b16 v[60:61], v119 offset:38784
    ds_read_b64_tr_b16 v[62:63], v5 offset:64768
    ds_read_b64 v[102:103], v100 offset:0
    ds_read_b64 v[104:105], v100 offset:8192
    ds_read_b64 v[106:107], v100 offset:16384
    s_waitcnt lgkmcnt(15)
    v_mfma_f32_4x4x4_16b_bf16 v[76:79], v[32:33], v[34:35], v[76:79]
    v_mfma_f32_4x4x4_16b_bf16 v[80:83], v[36:37], v[38:39], v[80:83]
    s_waitcnt lgkmcnt(13)
    v_mfma_f32_4x4x4_16b_bf16 v[72:75], v[40:41], v[42:43], v[72:75]
    s_waitcnt lgkmcnt(11)
    v_mfma_f32_4x4x4_16b_bf16 v[76:79], v[44:45], v[46:47], v[76:79]
    s_waitcnt lgkmcnt(9)
    v_mfma_f32_4x4x4_16b_bf16 v[80:83], v[48:49], v[50:51], v[80:83]
    s_waitcnt lgkmcnt(7)
    v_mfma_f32_4x4x4_16b_bf16 v[72:75], v[52:53], v[54:55], v[72:75]
    s_waitcnt lgkmcnt(5)
    v_mfma_f32_4x4x4_16b_bf16 v[76:79], v[56:57], v[58:59], v[76:79]
    s_waitcnt lgkmcnt(3)
    v_mfma_f32_4x4x4_16b_bf16 v[80:83], v[60:61], v[62:63], v[80:83]
    s_nop 0
    v_cndmask_b32 v72, v72, v74, s[16:17]
    v_cndmask_b32 v73, v73, v75, s[16:17]
    v_cndmask_b32 v76, v76, v78, s[16:17]
    v_cndmask_b32 v77, v77, v79, s[16:17]
    v_cndmask_b32 v80, v80, v82, s[16:17]
    v_cndmask_b32 v81, v81, v83, s[16:17]
    s_waitcnt lgkmcnt(0)
    v_add_f32 v72, v72, v102
    v_add_f32 v73, v73, v103
    v_add_f32 v76, v76, v104
    v_add_f32 v77, v77, v105
    v_add_f32 v80, v80, v106
    v_add_f32 v81, v81, v107
    v_mul_f32_dpp v74, v72, v8 quad_perm:[0,0,0,0] row_mask:0xf bank_mask:0xf
    v_mul_f32_dpp v75, v73, v8 quad_perm:[0,0,0,0] row_mask:0xf bank_mask:0xf
    v_mul_f32_dpp v78, v76, v8 quad_perm:[0,0,0,0] row_mask:0xf bank_mask:0xf
    v_mul_f32_dpp v79, v77, v8 quad_perm:[0,0,0,0] row_mask:0xf bank_mask:0xf
    v_mul_f32_dpp v82, v80, v8 quad_perm:[0,0,0,0] row_mask:0xf bank_mask:0xf
    v_mul_f32_dpp v83, v81, v8 quad_perm:[0,0,0,0] row_mask:0xf bank_mask:0xf
    v_fmac_f32_dpp v74, v72, v9 quad_perm:[1,1,1,1] row_mask:0xf bank_mask:0xf
    v_fmac_f32_dpp v75, v73, v9 quad_perm:[1,1,1,1] row_mask:0xf bank_mask:0xf
    v_fmac_f32_dpp v78, v76, v9 quad_perm:[1,1,1,1] row_mask:0xf bank_mask:0xf
    v_fmac_f32_dpp v79, v77, v9 quad_perm:[1,1,1,1] row_mask:0xf bank_mask:0xf
    v_fmac_f32_dpp v82, v80, v9 quad_perm:[1,1,1,1] row_mask:0xf bank_mask:0xf
    v_fmac_f32_dpp v83, v81, v9 quad_perm:[1,1,1,1] row_mask:0xf bank_mask:0xf
    v_fmac_f32_dpp v74, v72, v10 quad_perm:[2,2,2,2] row_mask:0xf bank_mask:0xf
    v_fmac_f32_dpp v75, v73, v10 quad_perm:[2,2,2,2] row_mask:0xf bank_mask:0xf
    v_fmac_f32_dpp v78, v76, v10 quad_perm:[2,2,2,2] row_mask:0xf bank_mask:0xf
    v_fmac_f32_dpp v79, v77, v10 quad_perm:[2,2,2,2] row_mask:0xf bank_mask:0xf
    v_fmac_f32_dpp v82, v80, v10 quad_perm:[2,2,2,2] row_mask:0xf bank_mask:0xf
    v_fmac_f32_dpp v83, v81, v10 quad_perm:[2,2,2,2] row_mask:0xf bank_mask:0xf
    v_fmac_f32_dpp v74, v72, v11 quad_perm:[3,3,3,3] row_mask:0xf bank_mask:0xf
    v_fmac_f32_dpp v75, v73, v11 quad_perm:[3,3,3,3] row_mask:0xf bank_mask:0xf
    v_fmac_f32_dpp v78, v76, v11 quad_perm:[3,3,3,3] row_mask:0xf bank_mask:0xf
    v_fmac_f32_dpp v79, v77, v11 quad_perm:[3,3,3,3] row_mask:0xf bank_mask:0xf
    v_fmac_f32_dpp v82, v80, v11 quad_perm:[3,3,3,3] row_mask:0xf bank_mask:0xf
    v_fmac_f32_dpp v83, v81, v11 quad_perm:[3,3,3,3] row_mask:0xf bank_mask:0xf
    v_mul_f32 v102, v84, v74
    v_mul_f32 v103, v85, v78
    v_mul_f32 v104, v86, v82
    v_fmac_f32 v102, v88, v75
    v_fmac_f32 v103, v89, v79
    v_fmac_f32 v104, v90, v83
    v_cvt_pk_bf16_f32 v103, v102, v103
    v_lshlrev_b32 v102, 16, v103
    v_and_b32 v103, 0xffff0000, v103
    v_cvt_pk_bf16_f32 v104, v104, v104
    v_and_b32 v104, 0xffff0000, v104
    v_mul_f32_dpp v106, v102, v12 quad_perm:[0,0,0,0] row_mask:0xf bank_mask:0xf
    v_mul_f32_dpp v107, v103, v12 quad_perm:[0,0,0,0] row_mask:0xf bank_mask:0xf
    v_mul_f32_dpp v108, v104, v12 quad_perm:[0,0,0,0] row_mask:0xf bank_mask:0xf
    v_fmac_f32_dpp v106, v102, v13 quad_perm:[1,1,1,1] row_mask:0xf bank_mask:0xf
    v_fmac_f32_dpp v107, v103, v13 quad_perm:[1,1,1,1] row_mask:0xf bank_mask:0xf
    v_fmac_f32_dpp v108, v104, v13 quad_perm:[1,1,1,1] row_mask:0xf bank_mask:0xf
    v_fmac_f32_dpp v106, v102, v14 quad_perm:[2,2,2,2] row_mask:0xf bank_mask:0xf
    v_fmac_f32_dpp v107, v103, v14 quad_perm:[2,2,2,2] row_mask:0xf bank_mask:0xf
    v_fmac_f32_dpp v108, v104, v14 quad_perm:[2,2,2,2] row_mask:0xf bank_mask:0xf
    v_fmac_f32_dpp v106, v102, v15 quad_perm:[3,3,3,3] row_mask:0xf bank_mask:0xf
    v_fmac_f32_dpp v107, v103, v15 quad_perm:[3,3,3,3] row_mask:0xf bank_mask:0xf
    v_fmac_f32_dpp v108, v104, v15 quad_perm:[3,3,3,3] row_mask:0xf bank_mask:0xf
    v_cvt_pk_bf16_f32 v107, v106, v107
    v_lshlrev_b32 v106, 16, v107
    v_and_b32 v107, 0xffff0000, v107
    v_cvt_pk_bf16_f32 v108, v108, v108
    v_and_b32 v108, 0xffff0000, v108
    v_mul_f32 v106, v106, v92
    v_mul_f32 v107, v107, v93
    v_mul_f32 v108, v108, v94
    v_cvt_pk_bf16_f32 v107, v106, v107
    v_lshlrev_b32 v106, 16, v107
    v_and_b32 v107, 0xffff0000, v107
    v_cvt_pk_bf16_f32 v108, v108, v108
    v_and_b32 v108, 0xffff0000, v108
    v_add_f32 v106, v106, v96
    v_add_f32 v107, v107, v97
    v_add_f32 v108, v108, v98
    v_cvt_pk_bf16_f32 v106, v106, v107
    buffer_store_short v106, v101, s[12:15], s2 offen
    buffer_store_short_d16_hi v106, v101, s[12:15], s2 offen offset:2048
    v_cvt_pk_bf16_f32 v108, v108, v108
    v_cmpx_gt_u32 vcc, 452, v0
    buffer_store_short v108, v101, s[12:15], s18 offen
    s_endpgm
k2_N:
    s_mov_b64 exec, -1
    v_and_b32 v102, 12, v0
    v_lshlrev_b32 v103, 1, v102
    v_lshlrev_b32 v102, 2, v102
    ds_read_b64_tr_b16 v[72:73], v102 offset:1088
    ds_read_b64_tr_b16 v[74:75], v102 offset:1152
    ds_read_b64_tr_b16 v[76:77], v102 offset:1096
    ds_read_b64_tr_b16 v[78:79], v102 offset:1160
    ds_read_b64_tr_b16 v[80:81], v103 offset:1024
    ds_read_b64_tr_b16 v[82:83], v103 offset:1056
    v_lshlrev_b32 v119, 16, v119
    v_subrev_f32 v106, 0x0, v119
    v_subrev_f32 v107, 0x3e120000, v119
    v_subrev_f32 v108, 0x3e920000, v119
    v_subrev_f32 v109, 0x3edb0000, v119
    v_subrev_f32 v110, 0x3f120000, v119
    v_subrev_f32 v111, 0x3f370000, v119
    v_subrev_f32 v112, 0x3f5b0000, v119
    v_subrev_f32 v113, 0x3f800000, v119
    v_cvt_pk_bf16_f32 v107, v106, v107
    v_lshlrev_b32 v106, 16, v107
    v_and_b32 v107, 0xffff0000, v107
    v_cvt_pk_bf16_f32 v109, v108, v109
    v_lshlrev_b32 v108, 16, v109
    v_and_b32 v109, 0xffff0000, v109
    v_cvt_pk_bf16_f32 v111, v110, v111
    v_lshlrev_b32 v110, 16, v111
    v_and_b32 v111, 0xffff0000, v111
    v_cvt_pk_bf16_f32 v113, v112, v113
    v_lshlrev_b32 v112, 16, v113
    v_and_b32 v113, 0xffff0000, v113
    v_mul_f32 v106, v106, v106
    v_mul_f32 v107, v107, v107
    v_mul_f32 v108, v108, v108
    v_mul_f32 v109, v109, v109
    v_mul_f32 v110, v110, v110
    v_mul_f32 v111, v111, v111
    v_mul_f32 v112, v112, v112
    v_mul_f32 v113, v113, v113
    v_cvt_pk_bf16_f32 v107, v106, v107
    v_lshlrev_b32 v106, 16, v107
    v_and_b32 v107, 0xffff0000, v107
    v_cvt_pk_bf16_f32 v109, v108, v109
    v_lshlrev_b32 v108, 16, v109
    v_and_b32 v109, 0xffff0000, v109
    v_cvt_pk_bf16_f32 v111, v110, v111
    v_lshlrev_b32 v110, 16, v111
    v_and_b32 v111, 0xffff0000, v111
    v_cvt_pk_bf16_f32 v113, v112, v113
    v_lshlrev_b32 v112, 16, v113
    v_and_b32 v113, 0xffff0000, v113
    v_mul_f32 v106, 0xc1200000, v106
    v_mul_f32 v107, 0xc1200000, v107
    v_mul_f32 v108, 0xc1200000, v108
    v_mul_f32 v109, 0xc1200000, v109
    v_mul_f32 v110, 0xc1200000, v110
    v_mul_f32 v111, 0xc1200000, v111
    v_mul_f32 v112, 0xc1200000, v112
    v_mul_f32 v113, 0xc1200000, v113
    v_cvt_pk_bf16_f32 v107, v106, v107
    v_lshlrev_b32 v106, 16, v107
    v_and_b32 v107, 0xffff0000, v107
    v_cvt_pk_bf16_f32 v109, v108, v109
    v_lshlrev_b32 v108, 16, v109
    v_and_b32 v109, 0xffff0000, v109
    v_cvt_pk_bf16_f32 v111, v110, v111
    v_lshlrev_b32 v110, 16, v111
    v_and_b32 v111, 0xffff0000, v111
    v_cvt_pk_bf16_f32 v113, v112, v113
    v_lshlrev_b32 v112, 16, v113
    v_and_b32 v113, 0xffff0000, v113
    v_mul_f32 v106, 0x3fb8aa3b, v106
    v_mul_f32 v107, 0x3fb8aa3b, v107
    v_mul_f32 v108, 0x3fb8aa3b, v108
    v_mul_f32 v109, 0x3fb8aa3b, v109
    v_mul_f32 v110, 0x3fb8aa3b, v110
    v_mul_f32 v111, 0x3fb8aa3b, v111
    v_mul_f32 v112, 0x3fb8aa3b, v112
    v_mul_f32 v113, 0x3fb8aa3b, v113
    v_exp_f32 v106, v106
    v_exp_f32 v107, v107
    v_exp_f32 v108, v108
    v_exp_f32 v109, v109
    v_exp_f32 v110, v110
    v_exp_f32 v111, v111
    v_exp_f32 v112, v112
    v_exp_f32 v113, v113
    v_cvt_pk_bf16_f32 v102, v106, v107
    v_cvt_pk_bf16_f32 v103, v108, v109
    v_cvt_pk_bf16_f32 v104, v110, v111
    v_cvt_pk_bf16_f32 v105, v112, v113
    s_waitcnt lgkmcnt(0)
    v_mfma_f32_4x4x4_16b_bf16 v[84:87], v[102:103], v[72:73], 0
    v_mfma_f32_4x4x4_16b_bf16 v[88:91], v[102:103], v[76:77], 0
    v_mfma_f32_4x4x4_16b_bf16 v[92:95], v[102:103], v[80:81], 0
    v_mfma_f32_4x4x4_16b_bf16 v[84:87], v[104:105], v[74:75], v[84:87]
    v_mfma_f32_4x4x4_16b_bf16 v[88:91], v[104:105], v[78:79], v[88:91]
    v_mfma_f32_4x4x4_16b_bf16 v[92:95], v[104:105], v[82:83], v[92:95]
    v_lshrrev_b32 v106, 4, v0
    v_and_b32 v107, 3, v0
    v_lshl_add_u32 v106, v106, 2, v107
    v_bfe_u32 v107, v0, 2, 2
    v_mul_u32_u24 v107, 632, v107
    v_add_u32 v106, v106, v107
    v_lshlrev_b32 v5, 3, v106
    v_add_u32 v5, 46848, v5
    v_and_b32 v106, -2, v106
    v_lshlrev_b32 v119, 2, v106
    v_add_f32 v88, v88, v88
    v_add_f32 v89, v89, v89
    v_cvt_pk_bf16_f32 v93, v92, v93
    v_lshlrev_b32 v92, 16, v93
    v_and_b32 v93, 0xffff0000, v93
    s_mov_b64 exec, -1
    v_and_b32 v108, 1, v0
    v_mul_u32_u24 v108, 0xffff, v108
    v_add_u32 v108, 1, v108
    v_mul_u32_u24 v108, 0x3f80, v108
    v_bfe_i32 v109, v0, 1, 1
    v_and_b32 v109, v109, v108
    v_xor_b32 v108, v109, v108
    v_mov_b32 v110, v96
    v_mov_b32 v111, v97
    s_nop 1
    v_mfma_f32_4x4x4_16b_bf16 v[96:99], v[110:111], v[108:109], 0
    s_mov_b64 exec, -1
    v_lshlrev_b32 v102, 4, v0
    v_add_u32 v102, 72192, v102
    v_mov_b32 v106, 0
    v_mov_b32 v107, 0
    v_mov_b32 v108, 0
    v_mov_b32 v109, 0
    ds_write_b128 v102, v[106:109] offset:0
    ds_write_b128 v102, v[106:109] offset:16384
    ds_write_b128 v102, v[106:109] offset:32768
    v_cmpx_gt_u32 vcc, 400, v0
    ds_write_b128 v102, v[106:109] offset:49152
    s_mov_b64 exec, 0xffff
    buffer_load_dword v101, v24, s[4:7], s79 offen sc1
    s_mov_b64 exec, 0xffff
    s_waitcnt vmcnt(0)
    v_cmp_eq_u32 vcc, 0, v101
    s_cbranch_vccnz k2_pwaitN
k2_pokN:
    v_and_b32 v100, 0xffff, v101
    v_lshrrev_b32 v101, 16, v101
    v_lshl_add_u32 v100, v100, 2, v6
    v_min_u32 v102, 63, v101
    v_readlane_b32 s36, v100, 0
    v_readlane_b32 s20, v102, 0
    v_readlane_b32 s37, v100, 1
    v_readlane_b32 s21, v102, 1
    v_readlane_b32 s38, v100, 2
    v_readlane_b32 s22, v102, 2
    v_readlane_b32 s39, v100, 3
    v_readlane_b32 s23, v102, 3
    v_readlane_b32 s40, v100, 4
    v_readlane_b32 s24, v102, 4
    v_readlane_b32 s41, v100, 5
    v_readlane_b32 s25, v102, 5
    v_readlane_b32 s42, v100, 6
    v_readlane_b32 s26, v102, 6
    v_readlane_b32 s43, v100, 7
    v_readlane_b32 s27, v102, 7
    v_readlane_b32 s44, v100, 8
    v_readlane_b32 s28, v102, 8
    v_readlane_b32 s45, v100, 9
    v_readlane_b32 s29, v102, 9
    v_readlane_b32 s46, v100, 10
    v_readlane_b32 s30, v102, 10
    v_readlane_b32 s47, v100, 11
    v_readlane_b32 s31, v102, 11
    v_readlane_b32 s48, v100, 12
    v_readlane_b32 s32, v102, 12
    v_readlane_b32 s49, v100, 13
    v_readlane_b32 s33, v102, 13
    v_readlane_b32 s50, v100, 14
    v_readlane_b32 s34, v102, 14
    v_readlane_b32 s51, v100, 15
    v_readlane_b32 s35, v102, 15
    s_bfm_b64 exec, s20, 0
    s_lshr_b32 vcc_lo, s36, 2
    buffer_load_ubyte v11, v2, s[4:7], vcc_lo offen sc1
    buffer_load_dword v10, v1, s[4:7], s36 offen sc1
    s_bfm_b64 exec, s21, 0
    s_lshr_b32 vcc_hi, s37, 2
    buffer_load_ubyte v15, v2, s[4:7], vcc_hi offen sc1
    buffer_load_dword v14, v1, s[4:7], s37 offen sc1
    s_bfm_b64 exec, s22, 0
    s_lshr_b32 vcc_lo, s38, 2
    buffer_load_ubyte v19, v2, s[4:7], vcc_lo offen sc1
    buffer_load_dword v18, v1, s[4:7], s38 offen sc1
    s_bfm_b64 exec, s23, 0
    s_lshr_b32 vcc_hi, s39, 2
    buffer_load_ubyte v23, v2, s[4:7], vcc_hi offen sc1
    buffer_load_dword v22, v1, s[4:7], s39 offen sc1
    s_bfm_b64 exec, s24, 0
    s_lshr_b32 vcc_lo, s40, 2
    buffer_load_ubyte v27, v2, s[4:7], vcc_lo offen sc1
    buffer_load_dword v26, v1, s[4:7], s40 offen sc1
    s_bfm_b64 exec, s25, 0
    s_lshr_b32 vcc_hi, s41, 2
    buffer_load_ubyte v31, v2, s[4:7], vcc_hi offen sc1
    buffer_load_dword v30, v1, s[4:7], s41 offen sc1
    s_bfm_b64 exec, s26, 0
    s_lshr_b32 vcc_lo, s42, 2
    buffer_load_ubyte v35, v2, s[4:7], vcc_lo offen sc1
    buffer_load_dword v34, v1, s[4:7], s42 offen sc1
    s_bfm_b64 exec, s27, 0
    s_lshr_b32 vcc_hi, s43, 2
    buffer_load_ubyte v39, v2, s[4:7], vcc_hi offen sc1
    buffer_load_dword v38, v1, s[4:7], s43 offen sc1
    s_bfm_b64 exec, s28, 0
    s_lshr_b32 vcc_lo, s44, 2
    buffer_load_ubyte v43, v2, s[4:7], vcc_lo offen sc1
    buffer_load_dword v42, v1, s[4:7], s44 offen sc1
    s_bfm_b64 exec, s29, 0
    s_lshr_b32 vcc_hi, s45, 2
    buffer_load_ubyte v47, v2, s[4:7], vcc_hi offen sc1
    buffer_load_dword v46, v1, s[4:7], s45 offen sc1
    s_bfm_b64 exec, s30, 0
    s_lshr_b32 vcc_lo, s46, 2
    buffer_load_ubyte v51, v2, s[4:7], vcc_lo offen sc1
    buffer_load_dword v50, v1, s[4:7], s46 offen sc1
    s_bfm_b64 exec, s31, 0
    s_lshr_b32 vcc_hi, s47, 2
    buffer_load_ubyte v55, v2, s[4:7], vcc_hi offen sc1
    buffer_load_dword v54, v1, s[4:7], s47 offen sc1
    s_bfm_b64 exec, s32, 0
    s_lshr_b32 vcc_lo, s48, 2
    buffer_load_ubyte v59, v2, s[4:7], vcc_lo offen sc1
    buffer_load_dword v58, v1, s[4:7], s48 offen sc1
    s_bfm_b64 exec, s33, 0
    s_lshr_b32 vcc_hi, s49, 2
    buffer_load_ubyte v63, v2, s[4:7], vcc_hi offen sc1
    buffer_load_dword v62, v1, s[4:7], s49 offen sc1
    s_bfm_b64 exec, s34, 0
    s_lshr_b32 vcc_lo, s50, 2
    buffer_load_ubyte v67, v2, s[4:7], vcc_lo offen sc1
    buffer_load_dword v66, v1, s[4:7], s50 offen sc1
    s_bfm_b64 exec, s35, 0
    s_lshr_b32 vcc_hi, s51, 2
    buffer_load_ubyte v71, v2, s[4:7], vcc_hi offen sc1
    buffer_load_dword v70, v1, s[4:7], s51 offen sc1
    s_mov_b64 exec, 0xffff
    v_cmp_lt_u32 vcc, 63, v101
    s_cbranch_vccnz k2_leftN
k2_leftrN:
    s_bfm_b64 exec, s20, 0
    s_waitcnt vmcnt(31)
    v_lshlrev_b32 v11, 2, v11
    ds_add_rtn_u32 v8, v11, v3 offset:0
    s_bfm_b64 exec, s21, 0
    s_waitcnt vmcnt(29)
    v_lshlrev_b32 v15, 2, v15
    ds_add_rtn_u32 v12, v15, v3 offset:0
    s_bfm_b64 exec, s22, 0
    s_waitcnt vmcnt(27)
    v_lshlrev_b32 v19, 2, v19
    ds_add_rtn_u32 v16, v19, v3 offset:0
    s_bfm_b64 exec, s20, 0
    s_waitcnt lgkmcnt(2)
    v_cmp_le_u32 vcc, 64764, v8
    s_cbranch_vccnz k2_soN0
k2_sorN0:
    ds_write_b32 v8, v10 offset:6400
    s_bfm_b64 exec, s23, 0
    s_waitcnt vmcnt(25)
    v_lshlrev_b32 v23, 2, v23
    ds_add_rtn_u32 v20, v23, v3 offset:0
    s_bfm_b64 exec, s21, 0
    s_waitcnt lgkmcnt(3)
    v_cmp_le_u32 vcc, 64764, v12
    s_cbranch_vccnz k2_soN1
k2_sorN1:
    ds_write_b32 v12, v14 offset:6400
    s_bfm_b64 exec, s24, 0
    s_waitcnt vmcnt(23)
    v_lshlrev_b32 v27, 2, v27
    ds_add_rtn_u32 v24, v27, v3 offset:0
    s_bfm_b64 exec, s22, 0
    s_waitcnt lgkmcnt(4)
    v_cmp_le_u32 vcc, 64764, v16
    s_cbranch_vccnz k2_soN2
k2_sorN2:
    ds_write_b32 v16, v18 offset:6400
    s_bfm_b64 exec, s25, 0
    s_waitcnt vmcnt(21)
    v_lshlrev_b32 v31, 2, v31
    ds_add_rtn_u32 v28, v31, v3 offset:0
    s_bfm_b64 exec, s23, 0
    s_waitcnt lgkmcnt(4)
    v_cmp_le_u32 vcc, 64764, v20
    s_cbranch_vccnz k2_soN3
k2_sorN3:
    ds_write_b32 v20, v22 offset:6400
    s_bfm_b64 exec, s26, 0
    s_waitcnt vmcnt(19)
    v_lshlrev_b32 v35, 2, v35
    ds_add_rtn_u32 v32, v35, v3 offset:0
    s_bfm_b64 exec, s24, 0
    s_waitcnt lgkmcnt(4)
    v_cmp_le_u32 vcc, 64764, v24
    s_cbranch_vccnz k2_soN4
k2_sorN4:
    ds_write_b32 v24, v26 offset:6400
    s_bfm_b64 exec, s27, 0
    s_waitcnt vmcnt(17)
    v_lshlrev_b32 v39, 2, v39
    ds_add_rtn_u32 v36, v39, v3 offset:0
    s_bfm_b64 exec, s25, 0
    s_waitcnt lgkmcnt(4)
    v_cmp_le_u32 vcc, 64764, v28
    s_cbranch_vccnz k2_soN5
k2_sorN5:
    ds_write_b32 v28, v30 offset:6400
    s_bfm_b64 exec, s28, 0
    s_waitcnt vmcnt(15)
    v_lshlrev_b32 v43, 2, v43
    ds_add_rtn_u32 v40, v43, v3 offset:0
    s_bfm_b64 exec, s26, 0
    s_waitcnt lgkmcnt(4)
    v_cmp_le_u32 vcc, 64764, v32
    s_cbranch_vccnz k2_soN6
k2_sorN6:
    ds_write_b32 v32, v34 offset:6400
    s_bfm_b64 exec, s29, 0
    s_waitcnt vmcnt(13)
    v_lshlrev_b32 v47, 2, v47
    ds_add_rtn_u32 v44, v47, v3 offset:0
    s_bfm_b64 exec, s27, 0
    s_waitcnt lgkmcnt(4)
    v_cmp_le_u32 vcc, 64764, v36
    s_cbranch_vccnz k2_soN7
k2_sorN7:
    ds_write_b32 v36, v38 offset:6400
    s_bfm_b64 exec, s30, 0
    s_waitcnt vmcnt(11)
    v_lshlrev_b32 v51, 2, v51
    ds_add_rtn_u32 v48, v51, v3 offset:0
    s_bfm_b64 exec, s28, 0
    s_waitcnt lgkmcnt(4)
    v_cmp_le_u32 vcc, 64764, v40
    s_cbranch_vccnz k2_soN8
k2_sorN8:
    ds_write_b32 v40, v42 offset:6400
    s_bfm_b64 exec, s31, 0
    s_waitcnt vmcnt(9)
    v_lshlrev_b32 v55, 2, v55
    ds_add_rtn_u32 v52, v55, v3 offset:0
    s_bfm_b64 exec, s29, 0
    s_waitcnt lgkmcnt(4)
    v_cmp_le_u32 vcc, 64764, v44
    s_cbranch_vccnz k2_soN9
k2_sorN9:
    ds_write_b32 v44, v46 offset:6400
    s_bfm_b64 exec, s32, 0
    s_waitcnt vmcnt(7)
    v_lshlrev_b32 v59, 2, v59
    ds_add_rtn_u32 v56, v59, v3 offset:0
    s_bfm_b64 exec, s30, 0
    s_waitcnt lgkmcnt(4)
    v_cmp_le_u32 vcc, 64764, v48
    s_cbranch_vccnz k2_soN10
k2_sorN10:
    ds_write_b32 v48, v50 offset:6400
    s_bfm_b64 exec, s33, 0
    s_waitcnt vmcnt(5)
    v_lshlrev_b32 v63, 2, v63
    ds_add_rtn_u32 v60, v63, v3 offset:0
    s_bfm_b64 exec, s31, 0
    s_waitcnt lgkmcnt(4)
    v_cmp_le_u32 vcc, 64764, v52
    s_cbranch_vccnz k2_soN11
k2_sorN11:
    ds_write_b32 v52, v54 offset:6400
    s_bfm_b64 exec, s34, 0
    s_waitcnt vmcnt(3)
    v_lshlrev_b32 v67, 2, v67
    ds_add_rtn_u32 v64, v67, v3 offset:0
    s_bfm_b64 exec, s32, 0
    s_waitcnt lgkmcnt(4)
    v_cmp_le_u32 vcc, 64764, v56
    s_cbranch_vccnz k2_soN12
k2_sorN12:
    ds_write_b32 v56, v58 offset:6400
    s_bfm_b64 exec, s35, 0
    s_waitcnt vmcnt(1)
    v_lshlrev_b32 v71, 2, v71
    ds_add_rtn_u32 v68, v71, v3 offset:0
    s_bfm_b64 exec, s33, 0
    s_waitcnt lgkmcnt(4)
    v_cmp_le_u32 vcc, 64764, v60
    s_cbranch_vccnz k2_soN13
k2_sorN13:
    ds_write_b32 v60, v62 offset:6400
    s_bfm_b64 exec, s34, 0
    s_waitcnt lgkmcnt(3)
    v_cmp_le_u32 vcc, 64764, v64
    s_cbranch_vccnz k2_soN14
k2_sorN14:
    ds_write_b32 v64, v66 offset:6400
    s_bfm_b64 exec, s35, 0
    s_waitcnt vmcnt(0) lgkmcnt(2)
    v_cmp_le_u32 vcc, 64764, v68
    s_cbranch_vccnz k2_soN15
k2_sorN15:
    ds_write_b32 v68, v70 offset:6400
    s_waitcnt lgkmcnt(0)
    s_barrier
    s_mov_b64 exec, 0xffff
    v_lshlrev_b32 v103, 2, v7
    ds_read_b32 v102, v103 offset:0
    s_mov_b64 exec, -1
    ds_wrxchg_rtn_b32 v10, v4, v118 offset:6400
    ds_wrxchg_rtn_b32 v14, v4, v118 offset:6464
    ds_wrxchg_rtn_b32 v18, v4, v118 offset:6528
    ds_wrxchg_rtn_b32 v22, v4, v118 offset:6592
    ds_wrxchg_rtn_b32 v26, v4, v118 offset:6656
    ds_wrxchg_rtn_b32 v30, v4, v118 offset:6720
    ds_wrxchg_rtn_b32 v34, v4, v118 offset:6784
    ds_wrxchg_rtn_b32 v38, v4, v118 offset:6848
    v_mul_u32_u24 v7, 5000, v7
    v_mov_b32 v3, 2528
    v_mov_b32 v1, 0x1ff8
    v_mov_b32 v2, 0xffc
    v_readlane_b32 s36, v7, 0
    v_readlane_b32 s37, v7, 1
    v_readlane_b32 s38, v7, 2
    v_readlane_b32 s39, v7, 3
    v_readlane_b32 s40, v7, 4
    v_readlane_b32 s41, v7, 5
    v_readlane_b32 s42, v7, 6
    v_readlane_b32 s43, v7, 7
    v_readlane_b32 s44, v7, 8
    v_readlane_b32 s45, v7, 9
    v_readlane_b32 s46, v7, 10
    v_readlane_b32 s47, v7, 11
    v_readlane_b32 s48, v7, 12
    v_readlane_b32 s49, v7, 13
    v_readlane_b32 s50, v7, 14
    v_readlane_b32 s51, v7, 15
    s_waitcnt lgkmcnt(8)
    v_min_u32 v102, 64764, v102
    v_mul_hi_u32_u24 v102, 4177985, v102
    ds_wrxchg_rtn_b32 v42, v4, v118 offset:6912
    ds_wrxchg_rtn_b32 v46, v4, v118 offset:6976
    ds_wrxchg_rtn_b32 v50, v4, v118 offset:7040
    ds_wrxchg_rtn_b32 v54, v4, v118 offset:7104
    ds_wrxchg_rtn_b32 v58, v4, v118 offset:7168
    ds_wrxchg_rtn_b32 v62, v4, v118 offset:7232
    ds_wrxchg_rtn_b32 v66, v4, v118 offset:7296
    ds_wrxchg_rtn_b32 v70, v4, v118 offset:7360
    v_readlane_b32 s20, v102, 0
    v_readlane_b32 s21, v102, 1
    v_readlane_b32 s22, v102, 2
    v_readlane_b32 s23, v102, 3
    v_readlane_b32 s24, v102, 4
    v_readlane_b32 s25, v102, 5
    v_readlane_b32 s26, v102, 6
    v_readlane_b32 s27, v102, 7
    v_readlane_b32 s28, v102, 8
    v_readlane_b32 s29, v102, 9
    v_readlane_b32 s30, v102, 10
    v_readlane_b32 s31, v102, 11
    v_readlane_b32 s32, v102, 12
    v_readlane_b32 s33, v102, 13
    v_readlane_b32 s34, v102, 14
    v_readlane_b32 s35, v102, 15
    s_bfm_b64 exec, s20, 0
    s_waitcnt lgkmcnt(15)
    v_lshrrev_b32 v102, 7, v10
    v_and_b32 v102, v1, v102
    buffer_load_dwordx2 v[8:9], v102, s[8:11], s36 offen
    v_lshlrev_b32 v103, 2, v10
    v_and_b32 v103, v2, v103
    ds_add_rtn_u32 v11, v103, v3 offset:1280
    v_cvt_f32_i32 v10, v10
    v_mul_f32 v10, 0x30002008, v10
    v_fma_f32 v104, v10, v10, -0.5
    v_cvt_pk_bf16_f32 v10, v10, v104
    s_bfm_b64 exec, s21, 0
    s_waitcnt lgkmcnt(15)
    v_lshrrev_b32 v102, 7, v14
    v_and_b32 v102, v1, v102
    buffer_load_dwordx2 v[12:13], v102, s[8:11], s37 offen
    v_lshlrev_b32 v103, 2, v14
    v_and_b32 v103, v2, v103
    ds_add_rtn_u32 v15, v103, v3 offset:1280
    v_cvt_f32_i32 v14, v14
    v_mul_f32 v14, 0x30002008, v14
    v_fma_f32 v104, v14, v14, -0.5
    v_cvt_pk_bf16_f32 v14, v14, v104
    s_bfm_b64 exec, s22, 0
    s_waitcnt lgkmcnt(15)
    v_lshrrev_b32 v102, 7, v18
    v_and_b32 v102, v1, v102
    buffer_load_dwordx2 v[16:17], v102, s[8:11], s38 offen
    v_lshlrev_b32 v103, 2, v18
    v_and_b32 v103, v2, v103
    ds_add_rtn_u32 v19, v103, v3 offset:1280
    v_cvt_f32_i32 v18, v18
    v_mul_f32 v18, 0x30002008, v18
    v_fma_f32 v104, v18, v18, -0.5
    v_cvt_pk_bf16_f32 v18, v18, v104
    s_bfm_b64 exec, s23, 0
    s_waitcnt lgkmcnt(15)
    v_lshrrev_b32 v102, 7, v22
    v_and_b32 v102, v1, v102
    buffer_load_dwordx2 v[20:21], v102, s[8:11], s39 offen
    v_lshlrev_b32 v103, 2, v22
    v_and_b32 v103, v2, v103
    ds_add_rtn_u32 v23, v103, v3 offset:1280
    v_cvt_f32_i32 v22, v22
    v_mul_f32 v22, 0x30002008, v22
    v_fma_f32 v104, v22, v22, -0.5
    v_cvt_pk_bf16_f32 v22, v22, v104
    s_waitcnt lgkmcnt(0)
    s_barrier
    s_bfm_b64 exec, s20, 0
    s_waitcnt vmcnt(3)
    v_cmp_le_u32 vcc, 40448, v11
    v_lshlrev_b32 v108, 1, v11
    s_cbranch_vccnz k2_ovN0
k2_ovrN0:
    ds_write_b32 v11, v10 offset:6400
    ds_write_b64 v108, v[8:9] offset:46848
    s_bfm_b64 exec, s24, 0
    v_lshrrev_b32 v102, 7, v26
    v_and_b32 v102, v1, v102
    buffer_load_dwordx2 v[24:25], v102, s[8:11], s40 offen
    v_lshlrev_b32 v103, 2, v26
    v_and_b32 v103, v2, v103
    ds_add_rtn_u32 v27, v103, v3 offset:1280
    v_cvt_f32_i32 v26, v26
    v_mul_f32 v26, 0x30002008, v26
    v_fma_f32 v104, v26, v26, -0.5
    v_cvt_pk_bf16_f32 v26, v26, v104
    s_bfm_b64 exec, s21, 0
    s_waitcnt vmcnt(3)
    v_cmp_le_u32 vcc, 40448, v15
    v_lshlrev_b32 v108, 1, v15
    s_cbranch_vccnz k2_ovN1
k2_ovrN1:
    ds_write_b32 v15, v14 offset:6400
    ds_write_b64 v108, v[12:13] offset:46848
    s_bfm_b64 exec, s25, 0
    v_lshrrev_b32 v102, 7, v30
    v_and_b32 v102, v1, v102
    buffer_load_dwordx2 v[28:29], v102, s[8:11], s41 offen
    v_lshlrev_b32 v103, 2, v30
    v_and_b32 v103, v2, v103
    ds_add_rtn_u32 v31, v103, v3 offset:1280
    v_cvt_f32_i32 v30, v30
    v_mul_f32 v30, 0x30002008, v30
    v_fma_f32 v104, v30, v30, -0.5
    v_cvt_pk_bf16_f32 v30, v30, v104
    s_bfm_b64 exec, s22, 0
    s_waitcnt vmcnt(3)
    v_cmp_le_u32 vcc, 40448, v19
    v_lshlrev_b32 v108, 1, v19
    s_cbranch_vccnz k2_ovN2
k2_ovrN2:
    ds_write_b32 v19, v18 offset:6400
    ds_write_b64 v108, v[16:17] offset:46848
    s_bfm_b64 exec, s26, 0
    v_lshrrev_b32 v102, 7, v34
    v_and_b32 v102, v1, v102
    buffer_load_dwordx2 v[32:33], v102, s[8:11], s42 offen
    v_lshlrev_b32 v103, 2, v34
    v_and_b32 v103, v2, v103
    ds_add_rtn_u32 v35, v103, v3 offset:1280
    v_cvt_f32_i32 v34, v34
    v_mul_f32 v34, 0x30002008, v34
    v_fma_f32 v104, v34, v34, -0.5
    v_cvt_pk_bf16_f32 v34, v34, v104
    s_bfm_b64 exec, s23, 0
    s_waitcnt vmcnt(3)
    v_cmp_le_u32 vcc, 40448, v23
    v_lshlrev_b32 v108, 1, v23
    s_cbranch_vccnz k2_ovN3
k2_ovrN3:
    ds_write_b32 v23, v22 offset:6400
    ds_write_b64 v108, v[20:21] offset:46848
    s_bfm_b64 exec, s27, 0
    v_lshrrev_b32 v102, 7, v38
    v_and_b32 v102, v1, v102
    buffer_load_dwordx2 v[36:37], v102, s[8:11], s43 offen
    v_lshlrev_b32 v103, 2, v38
    v_and_b32 v103, v2, v103
    ds_add_rtn_u32 v39, v103, v3 offset:1280
    v_cvt_f32_i32 v38, v38
    v_mul_f32 v38, 0x30002008, v38
    v_fma_f32 v104, v38, v38, -0.5
    v_cvt_pk_bf16_f32 v38, v38, v104
    s_barrier
    s_bfm_b64 exec, s28, 0
    v_lshrrev_b32 v102, 7, v42
    v_and_b32 v102, v1, v102
    buffer_load_dwordx2 v[40:41], v102, s[8:11], s44 offen
    v_lshlrev_b32 v103, 2, v42
    v_and_b32 v103, v2, v103
    ds_add_rtn_u32 v43, v103, v3 offset:3840
    v_cvt_f32_i32 v42, v42
    v_mul_f32 v42, 0x30002008, v42
    v_fma_f32 v104, v42, v42, -0.5
    v_cvt_pk_bf16_f32 v42, v42, v104
    s_bfm_b64 exec, s29, 0
    v_lshrrev_b32 v102, 7, v46
    v_and_b32 v102, v1, v102
    buffer_load_dwordx2 v[44:45], v102, s[8:11], s45 offen
    v_lshlrev_b32 v103, 2, v46
    v_and_b32 v103, v2, v103
    ds_add_rtn_u32 v47, v103, v3 offset:3840
    v_cvt_f32_i32 v46, v46
    v_mul_f32 v46, 0x30002008, v46
    v_fma_f32 v104, v46, v46, -0.5
    v_cvt_pk_bf16_f32 v46, v46, v104
    s_bfm_b64 exec, s24, 0
    s_waitcnt vmcnt(5) lgkmcnt(11)
    v_cmp_le_u32 vcc, 40448, v27
    v_lshlrev_b32 v108, 1, v27
    s_cbranch_vccnz k2_ovN4
k2_ovrN4:
    ds_write_b32 v27, v26 offset:6400
    ds_write_b64 v108, v[24:25] offset:46848
    s_bfm_b64 exec, s25, 0
    s_waitcnt vmcnt(4) lgkmcnt(10)
    v_cmp_le_u32 vcc, 40448, v31
    v_lshlrev_b32 v108, 1, v31
    s_cbranch_vccnz k2_ovN5
k2_ovrN5:
    ds_write_b32 v31, v30 offset:6400
    ds_write_b64 v108, v[28:29] offset:46848
    s_bfm_b64 exec, s26, 0
    s_waitcnt vmcnt(3) lgkmcnt(9)
    v_cmp_le_u32 vcc, 40448, v35
    v_lshlrev_b32 v108, 1, v35
    s_cbranch_vccnz k2_ovN6
k2_ovrN6:
    ds_write_b32 v35, v34 offset:6400
    ds_write_b64 v108, v[32:33] offset:46848
    s_bfm_b64 exec, s27, 0
    s_waitcnt vmcnt(2) lgkmcnt(8)
    v_cmp_le_u32 vcc, 40448, v39
    v_lshlrev_b32 v108, 1, v39
    s_cbranch_vccnz k2_ovN7
k2_ovrN7:
    ds_write_b32 v39, v38 offset:6400
    ds_write_b64 v108, v[36:37] offset:46848
    s_waitcnt lgkmcnt(0)
    s_barrier
    s_bfm_b64 exec, s30, 0
    v_lshrrev_b32 v102, 7, v50
    v_and_b32 v102, v1, v102
    buffer_load_dwordx2 v[48:49], v102, s[8:11], s46 offen
    v_lshlrev_b32 v103, 2, v50
    v_and_b32 v103, v2, v103
    ds_add_rtn_u32 v51, v103, v3 offset:3840
    v_cvt_f32_i32 v50, v50
    v_mul_f32 v50, 0x30002008, v50
    v_fma_f32 v104, v50, v50, -0.5
    v_cvt_pk_bf16_f32 v50, v50, v104
    s_bfm_b64 exec, s31, 0
    v_lshrrev_b32 v102, 7, v54
    v_and_b32 v102, v1, v102
    buffer_load_dwordx2 v[52:53], v102, s[8:11], s47 offen
    v_lshlrev_b32 v103, 2, v54
    v_and_b32 v103, v2, v103
    ds_add_rtn_u32 v55, v103, v3 offset:3840
    v_cvt_f32_i32 v54, v54
    v_mul_f32 v54, 0x30002008, v54
    v_fma_f32 v104, v54, v54, -0.5
    v_cvt_pk_bf16_f32 v54, v54, v104
    s_mov_b64 exec, -1
    ds_read_b64_tr_b16 v[8:9], v119 offset:6400
    ds_read_b64_tr_b16 v[10:11], v5 offset:0
    ds_read_b64_tr_b16 v[12:13], v119 offset:7424
    ds_read_b64_tr_b16 v[14:15], v5 offset:2048
    ds_read_b64_tr_b16 v[16:17], v119 offset:16512
    ds_read_b64_tr_b16 v[18:19], v5 offset:20224
    ds_read_b64_tr_b16 v[20:21], v119 offset:17536
    ds_read_b64_tr_b16 v[22:23], v5 offset:22272
    ds_read_b64_tr_b16 v[24:25], v119 offset:26624
    ds_read_b64_tr_b16 v[26:27], v5 offset:40448
    ds_read_b64_tr_b16 v[28:29], v119 offset:27648
    ds_read_b64_tr_b16 v[30:31], v5 offset:42496
    ds_read_b64_tr_b16 v[32:33], v119 offset:36736
    ds_read_b64_tr_b16 v[34:35], v5 offset:60672
    v_lshrrev_b32 v102, 6, v0
    v_and_b32 v103, 3, v0
    v_lshl_add_u32 v102, v102, 2, v103
    v_bfe_u32 v103, v0, 2, 4
    v_mul_u32_u24 v103, 2528, v103
    v_min_u32 v104, 29, v102
    v_lshl_add_u32 v102, v102, 4, v103
    v_lshl_add_u32 v104, v104, 4, v103
    v_mov_b32 v106, 0
    v_mov_b32 v107, 0
    v_mov_b32 v108, 0
    v_mov_b32 v109, 0
    ds_read_b64_tr_b16 v[36:37], v119 offset:37760
    ds_read_b64_tr_b16 v[38:39], v5 offset:62720
    ds_write_b128 v102, v[106:109] offset:6400
    ds_write_b128 v102, v[106:109] offset:7424
    s_waitcnt lgkmcnt(15)
    v_mfma_f32_4x4x4_16b_bf16 v[72:75], v[8:9], v[10:11], 0
    s_waitcnt lgkmcnt(14)
    v_mfma_f32_4x4x4_16b_bf16 v[76:79], v[12:13], v[14:15], 0
    s_waitcnt lgkmcnt(12)
    v_mfma_f32_4x4x4_16b_bf16 v[72:75], v[16:17], v[18:19], v[72:75]
    s_waitcnt lgkmcnt(10)
    v_mfma_f32_4x4x4_16b_bf16 v[76:79], v[20:21], v[22:23], v[76:79]
    s_waitcnt lgkmcnt(8)
    v_mfma_f32_4x4x4_16b_bf16 v[72:75], v[24:25], v[26:27], v[72:75]
    s_waitcnt lgkmcnt(6)
    v_mfma_f32_4x4x4_16b_bf16 v[76:79], v[28:29], v[30:31], v[76:79]
    s_waitcnt lgkmcnt(4)
    v_mfma_f32_4x4x4_16b_bf16 v[72:75], v[32:33], v[34:35], v[72:75]
    s_waitcnt lgkmcnt(2)
    v_mfma_f32_4x4x4_16b_bf16 v[76:79], v[36:37], v[38:39], v[76:79]
    s_waitcnt lgkmcnt(0)
    s_barrier
    s_bfm_b64 exec, s32, 0
    v_lshrrev_b32 v102, 7, v58
    v_and_b32 v102, v1, v102
    buffer_load_dwordx2 v[56:57], v102, s[8:11], s48 offen
    v_lshlrev_b32 v103, 2, v58
    v_and_b32 v103, v2, v103
    ds_add_rtn_u32 v59, v103, v3 offset:3840
    v_cvt_f32_i32 v58, v58
    v_mul_f32 v58, 0x30002008, v58
    v_fma_f32 v104, v58, v58, -0.5
    v_cvt_pk_bf16_f32 v58, v58, v104
    s_bfm_b64 exec, s28, 0
    s_waitcnt vmcnt(4)
    v_cmp_le_u32 vcc, 40448, v43
    v_lshlrev_b32 v108, 1, v43
    s_cbranch_vccnz k2_ovN8
k2_ovrN8:
    ds_write_b32 v43, v42 offset:6400
    ds_write_b64 v108, v[40:41] offset:46848
    s_bfm_b64 exec, s33, 0
    v_lshrrev_b32 v102, 7, v62
    v_and_b32 v102, v1, v102
    buffer_load_dwordx2 v[60:61], v102, s[8:11], s49 offen
    v_lshlrev_b32 v103, 2, v62
    v_and_b32 v103, v2, v103
    ds_add_rtn_u32 v63, v103, v3 offset:3840
    v_cvt_f32_i32 v62, v62
    v_mul_f32 v62, 0x30002008, v62
    v_fma_f32 v104, v62, v62, -0.5
    v_cvt_pk_bf16_f32 v62, v62, v104
    s_bfm_b64 exec, s29, 0
    s_waitcnt vmcnt(4)
    v_cmp_le_u32 vcc, 40448, v47
    v_lshlrev_b32 v108, 1, v47
    s_cbranch_vccnz k2_ovN9
k2_ovrN9:
    ds_write_b32 v47, v46 offset:6400
    ds_write_b64 v108, v[44:45] offset:46848
    s_bfm_b64 exec, s34, 0
    v_lshrrev_b32 v102, 7, v66
    v_and_b32 v102, v1, v102
    buffer_load_dwordx2 v[64:65], v102, s[8:11], s50 offen
    v_lshlrev_b32 v103, 2, v66
    v_and_b32 v103, v2, v103
    ds_add_rtn_u32 v67, v103, v3 offset:3840
    v_cvt_f32_i32 v66, v66
    v_mul_f32 v66, 0x30002008, v66
    v_fma_f32 v104, v66, v66, -0.5
    v_cvt_pk_bf16_f32 v66, v66, v104
    s_bfm_b64 exec, s30, 0
    s_waitcnt vmcnt(4)
    v_cmp_le_u32 vcc, 40448, v51
    v_lshlrev_b32 v108, 1, v51
    s_cbranch_vccnz k2_ovN10
k2_ovrN10:
    ds_write_b32 v51, v50 offset:6400
    ds_write_b64 v108, v[48:49] offset:46848
    s_bfm_b64 exec, s35, 0
    v_lshrrev_b32 v102, 7, v70
    v_and_b32 v102, v1, v102
    buffer_load_dwordx2 v[68:69], v102, s[8:11], s51 offen
    v_lshlrev_b32 v103, 2, v70
    v_and_b32 v103, v2, v103
    ds_add_rtn_u32 v71, v103, v3 offset:3840
    v_cvt_f32_i32 v70, v70
    v_mul_f32 v70, 0x30002008, v70
    v_fma_f32 v104, v70, v70, -0.5
    v_cvt_pk_bf16_f32 v70, v70, v104
    s_mov_b64 exec, -1
    v_and_b32 v102, 12, v0
    v_lshlrev_b32 v102, 1, v102
    ds_read_b64_tr_b16 v[10:11], v102 offset:1216
    ds_read_b64_tr_b16 v[14:15], v102 offset:1248
    v_lshlrev_b32 v100, 3, v0
    v_add_u32 v100, 127744, v100
    v_lshlrev_b32 v101, 1, v0
    s_add_u32 s18, s2, 4096
    s_mov_b32 s16, 0xf0f0f0f0
    s_mov_b32 s17, 0xf0f0f0f0
    s_waitcnt lgkmcnt(0)
    v_lshlrev_b32 v8, 16, v10
    v_and_b32 v9, 0xffff0000, v10
    v_lshlrev_b32 v10, 16, v11
    v_and_b32 v11, 0xffff0000, v11
    v_lshlrev_b32 v12, 16, v14
    v_and_b32 v13, 0xffff0000, v14
    v_lshlrev_b32 v14, 16, v15
    v_and_b32 v15, 0xffff0000, v15
    s_bfm_b64 exec, s31, 0
    s_waitcnt vmcnt(4)
    v_cmp_le_u32 vcc, 40448, v55
    v_lshlrev_b32 v108, 1, v55
    s_cbranch_vccnz k2_ovN11
k2_ovrN11:
    ds_write_b32 v55, v54 offset:6400
    ds_write_b64 v108, v[52:53] offset:46848
    s_bfm_b64 exec, s32, 0
    s_waitcnt vmcnt(3)
    v_cmp_le_u32 vcc, 40448, v59
    v_lshlrev_b32 v108, 1, v59
    s_cbranch_vccnz k2_ovN12
k2_ovrN12:
    ds_write_b32 v59, v58 offset:6400
    ds_write_b64 v108, v[56:57] offset:46848
    s_bfm_b64 exec, s33, 0
    s_waitcnt vmcnt(2)
    v_cmp_le_u32 vcc, 40448, v63
    v_lshlrev_b32 v108, 1, v63
    s_cbranch_vccnz k2_ovN13
k2_ovrN13:
    ds_write_b32 v63, v62 offset:6400
    ds_write_b64 v108, v[60:61] offset:46848
    s_bfm_b64 exec, s34, 0
    s_waitcnt vmcnt(1)
    v_cmp_le_u32 vcc, 40448, v67
    v_lshlrev_b32 v108, 1, v67
    s_cbranch_vccnz k2_ovN14
k2_ovrN14:
    ds_write_b32 v67, v66 offset:6400
    ds_write_b64 v108, v[64:65] offset:46848
    s_bfm_b64 exec, s35, 0
    s_waitcnt vmcnt(0)
    v_cmp_le_u32 vcc, 40448, v71
    v_lshlrev_b32 v108, 1, v71
    s_cbranch_vccnz k2_ovN15
k2_ovrN15:
    ds_write_b32 v71, v70 offset:6400
    ds_write_b64 v108, v[68:69] offset:46848
    s_waitcnt lgkmcnt(0)
    s_barrier
    s_mov_b64 exec, -1
    ds_read_b64_tr_b16 v[16:17], v119 offset:6400
    ds_read_b64_tr_b16 v[18:19], v5 offset:0
    ds_read_b64_tr_b16 v[20:21], v119 offset:7424
    ds_read_b64_tr_b16 v[22:23], v5 offset:2048
    ds_read_b64_tr_b16 v[24:25], v119 offset:16512
    ds_read_b64_tr_b16 v[26:27], v5 offset:20224
    ds_read_b64_tr_b16 v[28:29], v119 offset:17536
    ds_read_b64_tr_b16 v[30:31], v5 offset:22272
    ds_read_b64_tr_b16 v[32:33], v119 offset:26624
    ds_read_b64_tr_b16 v[34:35], v5 offset:40448
    ds_read_b64_tr_b16 v[36:37], v119 offset:27648
    ds_read_b64_tr_b16 v[38:39], v5 offset:42496
    ds_read_b64_tr_b16 v[40:41], v119 offset:36736
    ds_read_b64_tr_b16 v[42:43], v5 offset:60672
    ds_read_b64_tr_b16 v[44:45], v119 offset:37760
    ds_read_b64_tr_b16 v[46:47], v5 offset:62720
    ds_read_b64 v[102:103], v100 offset:0
    ds_read_b64 v[104:105], v100 offset:8192
    s_waitcnt lgkmcnt(15)
    v_mfma_f32_4x4x4_16b_bf16 v[72:75], v[16:17], v[18:19], v[72:75]
    s_waitcnt lgkmcnt(14)
    v_mfma_f32_4x4x4_16b_bf16 v[76:79], v[20:21], v[22:23], v[76:79]
    s_waitcnt lgkmcnt(12)
    v_mfma_f32_4x4x4_16b_bf16 v[72:75], v[24:25], v[26:27], v[72:75]
    s_waitcnt lgkmcnt(10)
    v_mfma_f32_4x4x4_16b_bf16 v[76:79], v[28:29], v[30:31], v[76:79]
    s_waitcnt lgkmcnt(8)
    v_mfma_f32_4x4x4_16b_bf16 v[72:75], v[32:33], v[34:35], v[72:75]
    s_waitcnt lgkmcnt(6)
    v_mfma_f32_4x4x4_16b_bf16 v[76:79], v[36:37], v[38:39], v[76:79]
    s_waitcnt lgkmcnt(4)
    v_mfma_f32_4x4x4_16b_bf16 v[72:75], v[40:41], v[42:43], v[72:75]
    s_waitcnt lgkmcnt(2)
    v_mfma_f32_4x4x4_16b_bf16 v[76:79], v[44:45], v[46:47], v[76:79]
    s_nop 2
    v_cndmask_b32 v72, v72, v74, s[16:17]
    v_cndmask_b32 v73, v73, v75, s[16:17]
    v_cndmask_b32 v76, v76, v78, s[16:17]
    v_cndmask_b32 v77, v77, v79, s[16:17]
    s_waitcnt lgkmcnt(0)
    v_add_f32 v72, v72, v102
    v_add_f32 v73, v73, v103
    v_add_f32 v76, v76, v104
    v_add_f32 v77, v77, v105
    v_mul_f32_dpp v74, v72, v8 quad_perm:[0,0,0,0] row_mask:0xf bank_mask:0xf
    v_mul_f32_dpp v75, v73, v8 quad_perm:[0,0,0,0] row_mask:0xf bank_mask:0xf
    v_mul_f32_dpp v78, v76, v8 quad_perm:[0,0,0,0] row_mask:0xf bank_mask:0xf
    v_mul_f32_dpp v79, v77, v8 quad_perm:[0,0,0,0] row_mask:0xf bank_mask:0xf
    v_fmac_f32_dpp v74, v72, v9 quad_perm:[1,1,1,1] row_mask:0xf bank_mask:0xf
    v_fmac_f32_dpp v75, v73, v9 quad_perm:[1,1,1,1] row_mask:0xf bank_mask:0xf
    v_fmac_f32_dpp v78, v76, v9 quad_perm:[1,1,1,1] row_mask:0xf bank_mask:0xf
    v_fmac_f32_dpp v79, v77, v9 quad_perm:[1,1,1,1] row_mask:0xf bank_mask:0xf
    v_fmac_f32_dpp v74, v72, v10 quad_perm:[2,2,2,2] row_mask:0xf bank_mask:0xf
    v_fmac_f32_dpp v75, v73, v10 quad_perm:[2,2,2,2] row_mask:0xf bank_mask:0xf
    v_fmac_f32_dpp v78, v76, v10 quad_perm:[2,2,2,2] row_mask:0xf bank_mask:0xf
    v_fmac_f32_dpp v79, v77, v10 quad_perm:[2,2,2,2] row_mask:0xf bank_mask:0xf
    v_fmac_f32_dpp v74, v72, v11 quad_perm:[3,3,3,3] row_mask:0xf bank_mask:0xf
    v_fmac_f32_dpp v75, v73, v11 quad_perm:[3,3,3,3] row_mask:0xf bank_mask:0xf
    v_fmac_f32_dpp v78, v76, v11 quad_perm:[3,3,3,3] row_mask:0xf bank_mask:0xf
    v_fmac_f32_dpp v79, v77, v11 quad_perm:[3,3,3,3] row_mask:0xf bank_mask:0xf
    v_mul_f32 v102, v84, v74
    v_mul_f32 v103, v85, v78
    v_fmac_f32 v102, v88, v75
    v_fmac_f32 v103, v89, v79
    v_cvt_pk_bf16_f32 v103, v102, v103
    v_lshlrev_b32 v102, 16, v103
    v_and_b32 v103, 0xffff0000, v103
    s_nop 0
    v_mul_f32_dpp v106, v102, v12 quad_perm:[0,0,0,0] row_mask:0xf bank_mask:0xf
    v_mul_f32_dpp v107, v103, v12 quad_perm:[0,0,0,0] row_mask:0xf bank_mask:0xf
    s_nop 0
    v_fmac_f32_dpp v106, v102, v13 quad_perm:[1,1,1,1] row_mask:0xf bank_mask:0xf
    v_fmac_f32_dpp v107, v103, v13 quad_perm:[1,1,1,1] row_mask:0xf bank_mask:0xf
    s_nop 0
    v_fmac_f32_dpp v106, v102, v14 quad_perm:[2,2,2,2] row_mask:0xf bank_mask:0xf
    v_fmac_f32_dpp v107, v103, v14 quad_perm:[2,2,2,2] row_mask:0xf bank_mask:0xf
    s_nop 0
    v_fmac_f32_dpp v106, v102, v15 quad_perm:[3,3,3,3] row_mask:0xf bank_mask:0xf
    v_fmac_f32_dpp v107, v103, v15 quad_perm:[3,3,3,3] row_mask:0xf bank_mask:0xf
    v_cvt_pk_bf16_f32 v107, v106, v107
    v_lshlrev_b32 v106, 16, v107
    v_and_b32 v107, 0xffff0000, v107
    v_mul_f32 v106, v106, v92
    v_mul_f32 v107, v107, v93
    v_cvt_pk_bf16_f32 v107, v106, v107
    v_lshlrev_b32 v106, 16, v107
    v_and_b32 v107, 0xffff0000, v107
    v_add_f32 v106, v106, v96
    v_add_f32 v107, v107, v97
    v_cvt_pk_bf16_f32 v106, v106, v107
    buffer_store_short v106, v101, s[12:15], s2 offen
    buffer_store_short_d16_hi v106, v101, s[12:15], s2 offen offset:2048
    s_endpgm
k2_end:
    s_endpgm
k1_cwait:
    s_sub_u32 s81, s81, 1
    s_cbranch_scc1 k2_end
    s_sleep 4
    global_load_dwordx2 v[76:77], v78, s[70:71] sc1
    s_waitcnt vmcnt(0)
    s_branch k1_cchk
k2_pwaitR:
    s_mov_b64 exec, vcc
    s_sub_u32 s81, s81, 1
    s_cbranch_scc1 k2_end
    s_sleep 4
    buffer_load_dword v101, v24, s[4:7], s79 offen sc1
    s_waitcnt vmcnt(0)
    v_cmp_eq_u32 vcc, 0, v101
    s_cbranch_vccnz k2_pwaitR
    s_mov_b64 exec, 0xffff
    s_branch k2_pokR
k2_leftR:
    s_mov_b64 s[36:37], vcc
k2_ljR:
    s_ff1_i32_b64 s38, s[36:37]
    s_bitset0_b64 s[36:37], s38
    v_readlane_b32 s39, v100, s38
    v_readlane_b32 s40, v101, s38
    s_nop 4
    s_sub_u32 s40, s40, 63
k2_lcR:
    s_add_u32 s39, s39, 252
    s_lshr_b32 s41, s39, 2
    s_min_u32 s42, s40, 63
    s_bfm_b64 exec, s42, 0
    buffer_load_dword v113, v1, s[4:7], s39 offen sc1
    buffer_load_ubyte v114, v2, s[4:7], s41 offen sc1
    s_waitcnt vmcnt(0)
    v_lshlrev_b32 v114, 2, v114
    v_lshrrev_b32 v107, 7, v113
    v_and_b32 v107, 0x1ff8, v107
    v_mul_u32_u24 v108, 1250, v114
    v_add_u32 v107, v107, v108
    buffer_load_dwordx2 v[110:111], v107, s[8:11], 0 offen
    v_cvt_f32_i32 v112, v113
    v_mul_f32 v112, 0x30002008, v112
    v_fma_f32 v108, v112, v112, -0.5
    v_cvt_pk_bf16_f32 v112, v112, v108
    v_and_b32 v107, 0x3ff, v113
    v_lshlrev_b32 v107, 2, v107
    s_waitcnt vmcnt(0)
    v_lshlrev_b32 v102, 3, v107
    v_add_u32 v102, 127744, v102
    v_lshlrev_b32 v107, 16, v112
    v_and_b32 v103, 0xffff0000, v112
    v_lshlrev_b32 v104, 16, v110
    v_mul_f32 v105, v107, v104
    ds_add_f32 v102, v105 offset:0
    v_mul_f32 v106, v103, v104
    ds_add_f32 v102, v106 offset:4
    v_and_b32 v104, 0xffff0000, v110
    v_mul_f32 v105, v107, v104
    ds_add_f32 v102, v105 offset:8
    v_mul_f32 v106, v103, v104
    ds_add_f32 v102, v106 offset:12
    v_lshlrev_b32 v104, 16, v111
    v_mul_f32 v105, v107, v104
    ds_add_f32 v102, v105 offset:16
    v_mul_f32 v106, v103, v104
    ds_add_f32 v102, v106 offset:20
    v_and_b32 v104, 0xffff0000, v111
    v_mul_f32 v105, v107, v104
    ds_add_f32 v102, v105 offset:24
    v_mul_f32 v106, v103, v104
    ds_add_f32 v102, v106 offset:28
    s_sub_u32 s40, s40, s42
    s_cmp_lg_u32 s40, 0
    s_cbranch_scc1 k2_lcR
    s_cmp_lg_u64 s[36:37], 0
    s_cbranch_scc1 k2_ljR
    s_branch k2_leftrR
k2_soR0:
    s_and_saveexec_b64 s[0:1], vcc
    v_lshrrev_b32 v107, 7, v10
    v_and_b32 v107, 0x1ff8, v107
    v_mul_u32_u24 v108, 1250, v11
    v_add_u32 v107, v107, v108
    buffer_load_dwordx2 v[110:111], v107, s[8:11], 0 offen
    v_cvt_f32_i32 v112, v10
    v_mul_f32 v112, 0x30002008, v112
    v_fma_f32 v108, v112, v112, -0.5
    v_cvt_pk_bf16_f32 v112, v112, v108
    v_and_b32 v107, 0x3ff, v10
    v_lshlrev_b32 v107, 2, v107
    s_waitcnt vmcnt(0)
    v_lshlrev_b32 v102, 3, v107
    v_add_u32 v102, 127744, v102
    v_lshlrev_b32 v107, 16, v112
    v_and_b32 v103, 0xffff0000, v112
    v_lshlrev_b32 v104, 16, v110
    v_mul_f32 v105, v107, v104
    ds_add_f32 v102, v105 offset:0
    v_mul_f32 v106, v103, v104
    ds_add_f32 v102, v106 offset:4
    v_and_b32 v104, 0xffff0000, v110
    v_mul_f32 v105, v107, v104
    ds_add_f32 v102, v105 offset:8
    v_mul_f32 v106, v103, v104
    ds_add_f32 v102, v106 offset:12
    v_lshlrev_b32 v104, 16, v111
    v_mul_f32 v105, v107, v104
    ds_add_f32 v102, v105 offset:16
    v_mul_f32 v106, v103, v104
    ds_add_f32 v102, v106 offset:20
    v_and_b32 v104, 0xffff0000, v111
    v_mul_f32 v105, v107, v104
    ds_add_f32 v102, v105 offset:24
    v_mul_f32 v106, v103, v104
    ds_add_f32 v102, v106 offset:28
    s_andn2_b64 exec, s[0:1], vcc
    s_branch k2_sorR0
k2_soR1:
    s_and_saveexec_b64 s[0:1], vcc
    v_lshrrev_b32 v107, 7, v14
    v_and_b32 v107, 0x1ff8, v107
    v_mul_u32_u24 v108, 1250, v15
    v_add_u32 v107, v107, v108
    buffer_load_dwordx2 v[110:111], v107, s[8:11], 0 offen
    v_cvt_f32_i32 v112, v14
    v_mul_f32 v112, 0x30002008, v112
    v_fma_f32 v108, v112, v112, -0.5
    v_cvt_pk_bf16_f32 v112, v112, v108
    v_and_b32 v107, 0x3ff, v14
    v_lshlrev_b32 v107, 2, v107
    s_waitcnt vmcnt(0)
    v_lshlrev_b32 v102, 3, v107
    v_add_u32 v102, 127744, v102
    v_lshlrev_b32 v107, 16, v112
    v_and_b32 v103, 0xffff0000, v112
    v_lshlrev_b32 v104, 16, v110
    v_mul_f32 v105, v107, v104
    ds_add_f32 v102, v105 offset:0
    v_mul_f32 v106, v103, v104
    ds_add_f32 v102, v106 offset:4
    v_and_b32 v104, 0xffff0000, v110
    v_mul_f32 v105, v107, v104
    ds_add_f32 v102, v105 offset:8
    v_mul_f32 v106, v103, v104
    ds_add_f32 v102, v106 offset:12
    v_lshlrev_b32 v104, 16, v111
    v_mul_f32 v105, v107, v104
    ds_add_f32 v102, v105 offset:16
    v_mul_f32 v106, v103, v104
    ds_add_f32 v102, v106 offset:20
    v_and_b32 v104, 0xffff0000, v111
    v_mul_f32 v105, v107, v104
    ds_add_f32 v102, v105 offset:24
    v_mul_f32 v106, v103, v104
    ds_add_f32 v102, v106 offset:28
    s_andn2_b64 exec, s[0:1], vcc
    s_branch k2_sorR1
k2_soR2:
    s_and_saveexec_b64 s[0:1], vcc
    v_lshrrev_b32 v107, 7, v18
    v_and_b32 v107, 0x1ff8, v107
    v_mul_u32_u24 v108, 1250, v19
    v_add_u32 v107, v107, v108
    buffer_load_dwordx2 v[110:111], v107, s[8:11], 0 offen
    v_cvt_f32_i32 v112, v18
    v_mul_f32 v112, 0x30002008, v112
    v_fma_f32 v108, v112, v112, -0.5
    v_cvt_pk_bf16_f32 v112, v112, v108
    v_and_b32 v107, 0x3ff, v18
    v_lshlrev_b32 v107, 2, v107
    s_waitcnt vmcnt(0)
    v_lshlrev_b32 v102, 3, v107
    v_add_u32 v102, 127744, v102
    v_lshlrev_b32 v107, 16, v112
    v_and_b32 v103, 0xffff0000, v112
    v_lshlrev_b32 v104, 16, v110
    v_mul_f32 v105, v107, v104
    ds_add_f32 v102, v105 offset:0
    v_mul_f32 v106, v103, v104
    ds_add_f32 v102, v106 offset:4
    v_and_b32 v104, 0xffff0000, v110
    v_mul_f32 v105, v107, v104
    ds_add_f32 v102, v105 offset:8
    v_mul_f32 v106, v103, v104
    ds_add_f32 v102, v106 offset:12
    v_lshlrev_b32 v104, 16, v111
    v_mul_f32 v105, v107, v104
    ds_add_f32 v102, v105 offset:16
    v_mul_f32 v106, v103, v104
    ds_add_f32 v102, v106 offset:20
    v_and_b32 v104, 0xffff0000, v111
    v_mul_f32 v105, v107, v104
    ds_add_f32 v102, v105 offset:24
    v_mul_f32 v106, v103, v104
    ds_add_f32 v102, v106 offset:28
    s_andn2_b64 exec, s[0:1], vcc
    s_branch k2_sorR2
k2_soR3:
    s_and_saveexec_b64 s[0:1], vcc
    v_lshrrev_b32 v107, 7, v22
    v_and_b32 v107, 0x1ff8, v107
    v_mul_u32_u24 v108, 1250, v23
    v_add_u32 v107, v107, v108
    buffer_load_dwordx2 v[110:111], v107, s[8:11], 0 offen
    v_cvt_f32_i32 v112, v22
    v_mul_f32 v112, 0x30002008, v112
    v_fma_f32 v108, v112, v112, -0.5
    v_cvt_pk_bf16_f32 v112, v112, v108
    v_and_b32 v107, 0x3ff, v22
    v_lshlrev_b32 v107, 2, v107
    s_waitcnt vmcnt(0)
    v_lshlrev_b32 v102, 3, v107
    v_add_u32 v102, 127744, v102
    v_lshlrev_b32 v107, 16, v112
    v_and_b32 v103, 0xffff0000, v112
    v_lshlrev_b32 v104, 16, v110
    v_mul_f32 v105, v107, v104
    ds_add_f32 v102, v105 offset:0
    v_mul_f32 v106, v103, v104
    ds_add_f32 v102, v106 offset:4
    v_and_b32 v104, 0xffff0000, v110
    v_mul_f32 v105, v107, v104
    ds_add_f32 v102, v105 offset:8
    v_mul_f32 v106, v103, v104
    ds_add_f32 v102, v106 offset:12
    v_lshlrev_b32 v104, 16, v111
    v_mul_f32 v105, v107, v104
    ds_add_f32 v102, v105 offset:16
    v_mul_f32 v106, v103, v104
    ds_add_f32 v102, v106 offset:20
    v_and_b32 v104, 0xffff0000, v111
    v_mul_f32 v105, v107, v104
    ds_add_f32 v102, v105 offset:24
    v_mul_f32 v106, v103, v104
    ds_add_f32 v102, v106 offset:28
    s_andn2_b64 exec, s[0:1], vcc
    s_branch k2_sorR3
k2_soR4:
    s_and_saveexec_b64 s[0:1], vcc
    v_lshrrev_b32 v107, 7, v26
    v_and_b32 v107, 0x1ff8, v107
    v_mul_u32_u24 v108, 1250, v27
    v_add_u32 v107, v107, v108
    buffer_load_dwordx2 v[110:111], v107, s[8:11], 0 offen
    v_cvt_f32_i32 v112, v26
    v_mul_f32 v112, 0x30002008, v112
    v_fma_f32 v108, v112, v112, -0.5
    v_cvt_pk_bf16_f32 v112, v112, v108
    v_and_b32 v107, 0x3ff, v26
    v_lshlrev_b32 v107, 2, v107
    s_waitcnt vmcnt(0)
    v_lshlrev_b32 v102, 3, v107
    v_add_u32 v102, 127744, v102
    v_lshlrev_b32 v107, 16, v112
    v_and_b32 v103, 0xffff0000, v112
    v_lshlrev_b32 v104, 16, v110
    v_mul_f32 v105, v107, v104
    ds_add_f32 v102, v105 offset:0
    v_mul_f32 v106, v103, v104
    ds_add_f32 v102, v106 offset:4
    v_and_b32 v104, 0xffff0000, v110
    v_mul_f32 v105, v107, v104
    ds_add_f32 v102, v105 offset:8
    v_mul_f32 v106, v103, v104
    ds_add_f32 v102, v106 offset:12
    v_lshlrev_b32 v104, 16, v111
    v_mul_f32 v105, v107, v104
    ds_add_f32 v102, v105 offset:16
    v_mul_f32 v106, v103, v104
    ds_add_f32 v102, v106 offset:20
    v_and_b32 v104, 0xffff0000, v111
    v_mul_f32 v105, v107, v104
    ds_add_f32 v102, v105 offset:24
    v_mul_f32 v106, v103, v104
    ds_add_f32 v102, v106 offset:28
    s_andn2_b64 exec, s[0:1], vcc
    s_branch k2_sorR4
k2_soR5:
    s_and_saveexec_b64 s[0:1], vcc
    v_lshrrev_b32 v107, 7, v30
    v_and_b32 v107, 0x1ff8, v107
    v_mul_u32_u24 v108, 1250, v31
    v_add_u32 v107, v107, v108
    buffer_load_dwordx2 v[110:111], v107, s[8:11], 0 offen
    v_cvt_f32_i32 v112, v30
    v_mul_f32 v112, 0x30002008, v112
    v_fma_f32 v108, v112, v112, -0.5
    v_cvt_pk_bf16_f32 v112, v112, v108
    v_and_b32 v107, 0x3ff, v30
    v_lshlrev_b32 v107, 2, v107
    s_waitcnt vmcnt(0)
    v_lshlrev_b32 v102, 3, v107
    v_add_u32 v102, 127744, v102
    v_lshlrev_b32 v107, 16, v112
    v_and_b32 v103, 0xffff0000, v112
    v_lshlrev_b32 v104, 16, v110
    v_mul_f32 v105, v107, v104
    ds_add_f32 v102, v105 offset:0
    v_mul_f32 v106, v103, v104
    ds_add_f32 v102, v106 offset:4
    v_and_b32 v104, 0xffff0000, v110
    v_mul_f32 v105, v107, v104
    ds_add_f32 v102, v105 offset:8
    v_mul_f32 v106, v103, v104
    ds_add_f32 v102, v106 offset:12
    v_lshlrev_b32 v104, 16, v111
    v_mul_f32 v105, v107, v104
    ds_add_f32 v102, v105 offset:16
    v_mul_f32 v106, v103, v104
    ds_add_f32 v102, v106 offset:20
    v_and_b32 v104, 0xffff0000, v111
    v_mul_f32 v105, v107, v104
    ds_add_f32 v102, v105 offset:24
    v_mul_f32 v106, v103, v104
    ds_add_f32 v102, v106 offset:28
    s_andn2_b64 exec, s[0:1], vcc
    s_branch k2_sorR5
k2_soR6:
    s_and_saveexec_b64 s[0:1], vcc
    v_lshrrev_b32 v107, 7, v34
    v_and_b32 v107, 0x1ff8, v107
    v_mul_u32_u24 v108, 1250, v35
    v_add_u32 v107, v107, v108
    buffer_load_dwordx2 v[110:111], v107, s[8:11], 0 offen
    v_cvt_f32_i32 v112, v34
    v_mul_f32 v112, 0x30002008, v112
    v_fma_f32 v108, v112, v112, -0.5
    v_cvt_pk_bf16_f32 v112, v112, v108
    v_and_b32 v107, 0x3ff, v34
    v_lshlrev_b32 v107, 2, v107
    s_waitcnt vmcnt(0)
    v_lshlrev_b32 v102, 3, v107
    v_add_u32 v102, 127744, v102
    v_lshlrev_b32 v107, 16, v112
    v_and_b32 v103, 0xffff0000, v112
    v_lshlrev_b32 v104, 16, v110
    v_mul_f32 v105, v107, v104
    ds_add_f32 v102, v105 offset:0
    v_mul_f32 v106, v103, v104
    ds_add_f32 v102, v106 offset:4
    v_and_b32 v104, 0xffff0000, v110
    v_mul_f32 v105, v107, v104
    ds_add_f32 v102, v105 offset:8
    v_mul_f32 v106, v103, v104
    ds_add_f32 v102, v106 offset:12
    v_lshlrev_b32 v104, 16, v111
    v_mul_f32 v105, v107, v104
    ds_add_f32 v102, v105 offset:16
    v_mul_f32 v106, v103, v104
    ds_add_f32 v102, v106 offset:20
    v_and_b32 v104, 0xffff0000, v111
    v_mul_f32 v105, v107, v104
    ds_add_f32 v102, v105 offset:24
    v_mul_f32 v106, v103, v104
    ds_add_f32 v102, v106 offset:28
    s_andn2_b64 exec, s[0:1], vcc
    s_branch k2_sorR6
k2_soR7:
    s_and_saveexec_b64 s[0:1], vcc
    v_lshrrev_b32 v107, 7, v38
    v_and_b32 v107, 0x1ff8, v107
    v_mul_u32_u24 v108, 1250, v39
    v_add_u32 v107, v107, v108
    buffer_load_dwordx2 v[110:111], v107, s[8:11], 0 offen
    v_cvt_f32_i32 v112, v38
    v_mul_f32 v112, 0x30002008, v112
    v_fma_f32 v108, v112, v112, -0.5
    v_cvt_pk_bf16_f32 v112, v112, v108
    v_and_b32 v107, 0x3ff, v38
    v_lshlrev_b32 v107, 2, v107
    s_waitcnt vmcnt(0)
    v_lshlrev_b32 v102, 3, v107
    v_add_u32 v102, 127744, v102
    v_lshlrev_b32 v107, 16, v112
    v_and_b32 v103, 0xffff0000, v112
    v_lshlrev_b32 v104, 16, v110
    v_mul_f32 v105, v107, v104
    ds_add_f32 v102, v105 offset:0
    v_mul_f32 v106, v103, v104
    ds_add_f32 v102, v106 offset:4
    v_and_b32 v104, 0xffff0000, v110
    v_mul_f32 v105, v107, v104
    ds_add_f32 v102, v105 offset:8
    v_mul_f32 v106, v103, v104
    ds_add_f32 v102, v106 offset:12
    v_lshlrev_b32 v104, 16, v111
    v_mul_f32 v105, v107, v104
    ds_add_f32 v102, v105 offset:16
    v_mul_f32 v106, v103, v104
    ds_add_f32 v102, v106 offset:20
    v_and_b32 v104, 0xffff0000, v111
    v_mul_f32 v105, v107, v104
    ds_add_f32 v102, v105 offset:24
    v_mul_f32 v106, v103, v104
    ds_add_f32 v102, v106 offset:28
    s_andn2_b64 exec, s[0:1], vcc
    s_branch k2_sorR7
k2_soR8:
    s_and_saveexec_b64 s[0:1], vcc
    v_lshrrev_b32 v107, 7, v42
    v_and_b32 v107, 0x1ff8, v107
    v_mul_u32_u24 v108, 1250, v43
    v_add_u32 v107, v107, v108
    buffer_load_dwordx2 v[110:111], v107, s[8:11], 0 offen
    v_cvt_f32_i32 v112, v42
    v_mul_f32 v112, 0x30002008, v112
    v_fma_f32 v108, v112, v112, -0.5
    v_cvt_pk_bf16_f32 v112, v112, v108
    v_and_b32 v107, 0x3ff, v42
    v_lshlrev_b32 v107, 2, v107
    s_waitcnt vmcnt(0)
    v_lshlrev_b32 v102, 3, v107
    v_add_u32 v102, 127744, v102
    v_lshlrev_b32 v107, 16, v112
    v_and_b32 v103, 0xffff0000, v112
    v_lshlrev_b32 v104, 16, v110
    v_mul_f32 v105, v107, v104
    ds_add_f32 v102, v105 offset:0
    v_mul_f32 v106, v103, v104
    ds_add_f32 v102, v106 offset:4
    v_and_b32 v104, 0xffff0000, v110
    v_mul_f32 v105, v107, v104
    ds_add_f32 v102, v105 offset:8
    v_mul_f32 v106, v103, v104
    ds_add_f32 v102, v106 offset:12
    v_lshlrev_b32 v104, 16, v111
    v_mul_f32 v105, v107, v104
    ds_add_f32 v102, v105 offset:16
    v_mul_f32 v106, v103, v104
    ds_add_f32 v102, v106 offset:20
    v_and_b32 v104, 0xffff0000, v111
    v_mul_f32 v105, v107, v104
    ds_add_f32 v102, v105 offset:24
    v_mul_f32 v106, v103, v104
    ds_add_f32 v102, v106 offset:28
    s_andn2_b64 exec, s[0:1], vcc
    s_branch k2_sorR8
k2_soR9:
    s_and_saveexec_b64 s[0:1], vcc
    v_lshrrev_b32 v107, 7, v46
    v_and_b32 v107, 0x1ff8, v107
    v_mul_u32_u24 v108, 1250, v47
    v_add_u32 v107, v107, v108
    buffer_load_dwordx2 v[110:111], v107, s[8:11], 0 offen
    v_cvt_f32_i32 v112, v46
    v_mul_f32 v112, 0x30002008, v112
    v_fma_f32 v108, v112, v112, -0.5
    v_cvt_pk_bf16_f32 v112, v112, v108
    v_and_b32 v107, 0x3ff, v46
    v_lshlrev_b32 v107, 2, v107
    s_waitcnt vmcnt(0)
    v_lshlrev_b32 v102, 3, v107
    v_add_u32 v102, 127744, v102
    v_lshlrev_b32 v107, 16, v112
    v_and_b32 v103, 0xffff0000, v112
    v_lshlrev_b32 v104, 16, v110
    v_mul_f32 v105, v107, v104
    ds_add_f32 v102, v105 offset:0
    v_mul_f32 v106, v103, v104
    ds_add_f32 v102, v106 offset:4
    v_and_b32 v104, 0xffff0000, v110
    v_mul_f32 v105, v107, v104
    ds_add_f32 v102, v105 offset:8
    v_mul_f32 v106, v103, v104
    ds_add_f32 v102, v106 offset:12
    v_lshlrev_b32 v104, 16, v111
    v_mul_f32 v105, v107, v104
    ds_add_f32 v102, v105 offset:16
    v_mul_f32 v106, v103, v104
    ds_add_f32 v102, v106 offset:20
    v_and_b32 v104, 0xffff0000, v111
    v_mul_f32 v105, v107, v104
    ds_add_f32 v102, v105 offset:24
    v_mul_f32 v106, v103, v104
    ds_add_f32 v102, v106 offset:28
    s_andn2_b64 exec, s[0:1], vcc
    s_branch k2_sorR9
k2_soR10:
    s_and_saveexec_b64 s[0:1], vcc
    v_lshrrev_b32 v107, 7, v50
    v_and_b32 v107, 0x1ff8, v107
    v_mul_u32_u24 v108, 1250, v51
    v_add_u32 v107, v107, v108
    buffer_load_dwordx2 v[110:111], v107, s[8:11], 0 offen
    v_cvt_f32_i32 v112, v50
    v_mul_f32 v112, 0x30002008, v112
    v_fma_f32 v108, v112, v112, -0.5
    v_cvt_pk_bf16_f32 v112, v112, v108
    v_and_b32 v107, 0x3ff, v50
    v_lshlrev_b32 v107, 2, v107
    s_waitcnt vmcnt(0)
    v_lshlrev_b32 v102, 3, v107
    v_add_u32 v102, 127744, v102
    v_lshlrev_b32 v107, 16, v112
    v_and_b32 v103, 0xffff0000, v112
    v_lshlrev_b32 v104, 16, v110
    v_mul_f32 v105, v107, v104
    ds_add_f32 v102, v105 offset:0
    v_mul_f32 v106, v103, v104
    ds_add_f32 v102, v106 offset:4
    v_and_b32 v104, 0xffff0000, v110
    v_mul_f32 v105, v107, v104
    ds_add_f32 v102, v105 offset:8
    v_mul_f32 v106, v103, v104
    ds_add_f32 v102, v106 offset:12
    v_lshlrev_b32 v104, 16, v111
    v_mul_f32 v105, v107, v104
    ds_add_f32 v102, v105 offset:16
    v_mul_f32 v106, v103, v104
    ds_add_f32 v102, v106 offset:20
    v_and_b32 v104, 0xffff0000, v111
    v_mul_f32 v105, v107, v104
    ds_add_f32 v102, v105 offset:24
    v_mul_f32 v106, v103, v104
    ds_add_f32 v102, v106 offset:28
    s_andn2_b64 exec, s[0:1], vcc
    s_branch k2_sorR10
k2_soR11:
    s_and_saveexec_b64 s[0:1], vcc
    v_lshrrev_b32 v107, 7, v54
    v_and_b32 v107, 0x1ff8, v107
    v_mul_u32_u24 v108, 1250, v55
    v_add_u32 v107, v107, v108
    buffer_load_dwordx2 v[110:111], v107, s[8:11], 0 offen
    v_cvt_f32_i32 v112, v54
    v_mul_f32 v112, 0x30002008, v112
    v_fma_f32 v108, v112, v112, -0.5
    v_cvt_pk_bf16_f32 v112, v112, v108
    v_and_b32 v107, 0x3ff, v54
    v_lshlrev_b32 v107, 2, v107
    s_waitcnt vmcnt(0)
    v_lshlrev_b32 v102, 3, v107
    v_add_u32 v102, 127744, v102
    v_lshlrev_b32 v107, 16, v112
    v_and_b32 v103, 0xffff0000, v112
    v_lshlrev_b32 v104, 16, v110
    v_mul_f32 v105, v107, v104
    ds_add_f32 v102, v105 offset:0
    v_mul_f32 v106, v103, v104
    ds_add_f32 v102, v106 offset:4
    v_and_b32 v104, 0xffff0000, v110
    v_mul_f32 v105, v107, v104
    ds_add_f32 v102, v105 offset:8
    v_mul_f32 v106, v103, v104
    ds_add_f32 v102, v106 offset:12
    v_lshlrev_b32 v104, 16, v111
    v_mul_f32 v105, v107, v104
    ds_add_f32 v102, v105 offset:16
    v_mul_f32 v106, v103, v104
    ds_add_f32 v102, v106 offset:20
    v_and_b32 v104, 0xffff0000, v111
    v_mul_f32 v105, v107, v104
    ds_add_f32 v102, v105 offset:24
    v_mul_f32 v106, v103, v104
    ds_add_f32 v102, v106 offset:28
    s_andn2_b64 exec, s[0:1], vcc
    s_branch k2_sorR11
k2_soR12:
    s_and_saveexec_b64 s[0:1], vcc
    v_lshrrev_b32 v107, 7, v58
    v_and_b32 v107, 0x1ff8, v107
    v_mul_u32_u24 v108, 1250, v59
    v_add_u32 v107, v107, v108
    buffer_load_dwordx2 v[110:111], v107, s[8:11], 0 offen
    v_cvt_f32_i32 v112, v58
    v_mul_f32 v112, 0x30002008, v112
    v_fma_f32 v108, v112, v112, -0.5
    v_cvt_pk_bf16_f32 v112, v112, v108
    v_and_b32 v107, 0x3ff, v58
    v_lshlrev_b32 v107, 2, v107
    s_waitcnt vmcnt(0)
    v_lshlrev_b32 v102, 3, v107
    v_add_u32 v102, 127744, v102
    v_lshlrev_b32 v107, 16, v112
    v_and_b32 v103, 0xffff0000, v112
    v_lshlrev_b32 v104, 16, v110
    v_mul_f32 v105, v107, v104
    ds_add_f32 v102, v105 offset:0
    v_mul_f32 v106, v103, v104
    ds_add_f32 v102, v106 offset:4
    v_and_b32 v104, 0xffff0000, v110
    v_mul_f32 v105, v107, v104
    ds_add_f32 v102, v105 offset:8
    v_mul_f32 v106, v103, v104
    ds_add_f32 v102, v106 offset:12
    v_lshlrev_b32 v104, 16, v111
    v_mul_f32 v105, v107, v104
    ds_add_f32 v102, v105 offset:16
    v_mul_f32 v106, v103, v104
    ds_add_f32 v102, v106 offset:20
    v_and_b32 v104, 0xffff0000, v111
    v_mul_f32 v105, v107, v104
    ds_add_f32 v102, v105 offset:24
    v_mul_f32 v106, v103, v104
    ds_add_f32 v102, v106 offset:28
    s_andn2_b64 exec, s[0:1], vcc
    s_branch k2_sorR12
k2_soR13:
    s_and_saveexec_b64 s[0:1], vcc
    v_lshrrev_b32 v107, 7, v62
    v_and_b32 v107, 0x1ff8, v107
    v_mul_u32_u24 v108, 1250, v63
    v_add_u32 v107, v107, v108
    buffer_load_dwordx2 v[110:111], v107, s[8:11], 0 offen
    v_cvt_f32_i32 v112, v62
    v_mul_f32 v112, 0x30002008, v112
    v_fma_f32 v108, v112, v112, -0.5
    v_cvt_pk_bf16_f32 v112, v112, v108
    v_and_b32 v107, 0x3ff, v62
    v_lshlrev_b32 v107, 2, v107
    s_waitcnt vmcnt(0)
    v_lshlrev_b32 v102, 3, v107
    v_add_u32 v102, 127744, v102
    v_lshlrev_b32 v107, 16, v112
    v_and_b32 v103, 0xffff0000, v112
    v_lshlrev_b32 v104, 16, v110
    v_mul_f32 v105, v107, v104
    ds_add_f32 v102, v105 offset:0
    v_mul_f32 v106, v103, v104
    ds_add_f32 v102, v106 offset:4
    v_and_b32 v104, 0xffff0000, v110
    v_mul_f32 v105, v107, v104
    ds_add_f32 v102, v105 offset:8
    v_mul_f32 v106, v103, v104
    ds_add_f32 v102, v106 offset:12
    v_lshlrev_b32 v104, 16, v111
    v_mul_f32 v105, v107, v104
    ds_add_f32 v102, v105 offset:16
    v_mul_f32 v106, v103, v104
    ds_add_f32 v102, v106 offset:20
    v_and_b32 v104, 0xffff0000, v111
    v_mul_f32 v105, v107, v104
    ds_add_f32 v102, v105 offset:24
    v_mul_f32 v106, v103, v104
    ds_add_f32 v102, v106 offset:28
    s_andn2_b64 exec, s[0:1], vcc
    s_branch k2_sorR13
k2_soR14:
    s_and_saveexec_b64 s[0:1], vcc
    v_lshrrev_b32 v107, 7, v66
    v_and_b32 v107, 0x1ff8, v107
    v_mul_u32_u24 v108, 1250, v67
    v_add_u32 v107, v107, v108
    buffer_load_dwordx2 v[110:111], v107, s[8:11], 0 offen
    v_cvt_f32_i32 v112, v66
    v_mul_f32 v112, 0x30002008, v112
    v_fma_f32 v108, v112, v112, -0.5
    v_cvt_pk_bf16_f32 v112, v112, v108
    v_and_b32 v107, 0x3ff, v66
    v_lshlrev_b32 v107, 2, v107
    s_waitcnt vmcnt(0)
    v_lshlrev_b32 v102, 3, v107
    v_add_u32 v102, 127744, v102
    v_lshlrev_b32 v107, 16, v112
    v_and_b32 v103, 0xffff0000, v112
    v_lshlrev_b32 v104, 16, v110
    v_mul_f32 v105, v107, v104
    ds_add_f32 v102, v105 offset:0
    v_mul_f32 v106, v103, v104
    ds_add_f32 v102, v106 offset:4
    v_and_b32 v104, 0xffff0000, v110
    v_mul_f32 v105, v107, v104
    ds_add_f32 v102, v105 offset:8
    v_mul_f32 v106, v103, v104
    ds_add_f32 v102, v106 offset:12
    v_lshlrev_b32 v104, 16, v111
    v_mul_f32 v105, v107, v104
    ds_add_f32 v102, v105 offset:16
    v_mul_f32 v106, v103, v104
    ds_add_f32 v102, v106 offset:20
    v_and_b32 v104, 0xffff0000, v111
    v_mul_f32 v105, v107, v104
    ds_add_f32 v102, v105 offset:24
    v_mul_f32 v106, v103, v104
    ds_add_f32 v102, v106 offset:28
    s_andn2_b64 exec, s[0:1], vcc
    s_branch k2_sorR14
k2_soR15:
    s_and_saveexec_b64 s[0:1], vcc
    v_lshrrev_b32 v107, 7, v70
    v_and_b32 v107, 0x1ff8, v107
    v_mul_u32_u24 v108, 1250, v71
    v_add_u32 v107, v107, v108
    buffer_load_dwordx2 v[110:111], v107, s[8:11], 0 offen
    v_cvt_f32_i32 v112, v70
    v_mul_f32 v112, 0x30002008, v112
    v_fma_f32 v108, v112, v112, -0.5
    v_cvt_pk_bf16_f32 v112, v112, v108
    v_and_b32 v107, 0x3ff, v70
    v_lshlrev_b32 v107, 2, v107
    s_waitcnt vmcnt(0)
    v_lshlrev_b32 v102, 3, v107
    v_add_u32 v102, 127744, v102
    v_lshlrev_b32 v107, 16, v112
    v_and_b32 v103, 0xffff0000, v112
    v_lshlrev_b32 v104, 16, v110
    v_mul_f32 v105, v107, v104
    ds_add_f32 v102, v105 offset:0
    v_mul_f32 v106, v103, v104
    ds_add_f32 v102, v106 offset:4
    v_and_b32 v104, 0xffff0000, v110
    v_mul_f32 v105, v107, v104
    ds_add_f32 v102, v105 offset:8
    v_mul_f32 v106, v103, v104
    ds_add_f32 v102, v106 offset:12
    v_lshlrev_b32 v104, 16, v111
    v_mul_f32 v105, v107, v104
    ds_add_f32 v102, v105 offset:16
    v_mul_f32 v106, v103, v104
    ds_add_f32 v102, v106 offset:20
    v_and_b32 v104, 0xffff0000, v111
    v_mul_f32 v105, v107, v104
    ds_add_f32 v102, v105 offset:24
    v_mul_f32 v106, v103, v104
    ds_add_f32 v102, v106 offset:28
    s_andn2_b64 exec, s[0:1], vcc
    s_branch k2_sorR15
k2_ovR0:
    s_and_saveexec_b64 s[0:1], vcc
    v_mov_b32 v107, 1698959
    v_mul_hi_u32 v107, v107, v11
    v_mul_u32_u24 v107, 2528, v107
    v_sub_u32 v107, v11, v107
    v_lshlrev_b32 v102, 3, v107
    v_add_u32 v102, 127744, v102
    v_lshlrev_b32 v107, 16, v10
    v_and_b32 v103, 0xffff0000, v10
    v_lshlrev_b32 v104, 16, v8
    v_mul_f32 v105, v107, v104
    ds_add_f32 v102, v105 offset:0
    v_mul_f32 v106, v103, v104
    ds_add_f32 v102, v106 offset:4
    v_and_b32 v104, 0xffff0000, v8
    v_mul_f32 v105, v107, v104
    ds_add_f32 v102, v105 offset:8
    v_mul_f32 v106, v103, v104
    ds_add_f32 v102, v106 offset:12
    v_lshlrev_b32 v104, 16, v9
    v_mul_f32 v105, v107, v104
    ds_add_f32 v102, v105 offset:16
    v_mul_f32 v106, v103, v104
    ds_add_f32 v102, v106 offset:20
    v_and_b32 v104, 0xffff0000, v9
    v_mul_f32 v105, v107, v104
    ds_add_f32 v102, v105 offset:24
    v_mul_f32 v106, v103, v104
    ds_add_f32 v102, v106 offset:28
    s_andn2_b64 exec, s[0:1], vcc
    s_branch k2_ovrR0
k2_ovR1:
    s_and_saveexec_b64 s[0:1], vcc
    v_mov_b32 v107, 1698959
    v_mul_hi_u32 v107, v107, v15
    v_mul_u32_u24 v107, 2528, v107
    v_sub_u32 v107, v15, v107
    v_lshlrev_b32 v102, 3, v107
    v_add_u32 v102, 127744, v102
    v_lshlrev_b32 v107, 16, v14
    v_and_b32 v103, 0xffff0000, v14
    v_lshlrev_b32 v104, 16, v12
    v_mul_f32 v105, v107, v104
    ds_add_f32 v102, v105 offset:0
    v_mul_f32 v106, v103, v104
    ds_add_f32 v102, v106 offset:4
    v_and_b32 v104, 0xffff0000, v12
    v_mul_f32 v105, v107, v104
    ds_add_f32 v102, v105 offset:8
    v_mul_f32 v106, v103, v104
    ds_add_f32 v102, v106 offset:12
    v_lshlrev_b32 v104, 16, v13
    v_mul_f32 v105, v107, v104
    ds_add_f32 v102, v105 offset:16
    v_mul_f32 v106, v103, v104
    ds_add_f32 v102, v106 offset:20
    v_and_b32 v104, 0xffff0000, v13
    v_mul_f32 v105, v107, v104
    ds_add_f32 v102, v105 offset:24
    v_mul_f32 v106, v103, v104
    ds_add_f32 v102, v106 offset:28
    s_andn2_b64 exec, s[0:1], vcc
    s_branch k2_ovrR1
k2_ovR2:
    s_and_saveexec_b64 s[0:1], vcc
    v_mov_b32 v107, 1698959
    v_mul_hi_u32 v107, v107, v19
    v_mul_u32_u24 v107, 2528, v107
    v_sub_u32 v107, v19, v107
    v_lshlrev_b32 v102, 3, v107
    v_add_u32 v102, 127744, v102
    v_lshlrev_b32 v107, 16, v18
    v_and_b32 v103, 0xffff0000, v18
    v_lshlrev_b32 v104, 16, v16
    v_mul_f32 v105, v107, v104
    ds_add_f32 v102, v105 offset:0
    v_mul_f32 v106, v103, v104
    ds_add_f32 v102, v106 offset:4
    v_and_b32 v104, 0xffff0000, v16
    v_mul_f32 v105, v107, v104
    ds_add_f32 v102, v105 offset:8
    v_mul_f32 v106, v103, v104
    ds_add_f32 v102, v106 offset:12
    v_lshlrev_b32 v104, 16, v17
    v_mul_f32 v105, v107, v104
    ds_add_f32 v102, v105 offset:16
    v_mul_f32 v106, v103, v104
    ds_add_f32 v102, v106 offset:20
    v_and_b32 v104, 0xffff0000, v17
    v_mul_f32 v105, v107, v104
    ds_add_f32 v102, v105 offset:24
    v_mul_f32 v106, v103, v104
    ds_add_f32 v102, v106 offset:28
    s_andn2_b64 exec, s[0:1], vcc
    s_branch k2_ovrR2
k2_ovR3:
    s_and_saveexec_b64 s[0:1], vcc
    v_mov_b32 v107, 1698959
    v_mul_hi_u32 v107, v107, v23
    v_mul_u32_u24 v107, 2528, v107
    v_sub_u32 v107, v23, v107
    v_lshlrev_b32 v102, 3, v107
    v_add_u32 v102, 127744, v102
    v_lshlrev_b32 v107, 16, v22
    v_and_b32 v103, 0xffff0000, v22
    v_lshlrev_b32 v104, 16, v20
    v_mul_f32 v105, v107, v104
    ds_add_f32 v102, v105 offset:0
    v_mul_f32 v106, v103, v104
    ds_add_f32 v102, v106 offset:4
    v_and_b32 v104, 0xffff0000, v20
    v_mul_f32 v105, v107, v104
    ds_add_f32 v102, v105 offset:8
    v_mul_f32 v106, v103, v104
    ds_add_f32 v102, v106 offset:12
    v_lshlrev_b32 v104, 16, v21
    v_mul_f32 v105, v107, v104
    ds_add_f32 v102, v105 offset:16
    v_mul_f32 v106, v103, v104
    ds_add_f32 v102, v106 offset:20
    v_and_b32 v104, 0xffff0000, v21
    v_mul_f32 v105, v107, v104
    ds_add_f32 v102, v105 offset:24
    v_mul_f32 v106, v103, v104
    ds_add_f32 v102, v106 offset:28
    s_andn2_b64 exec, s[0:1], vcc
    s_branch k2_ovrR3
k2_ovR4:
    s_and_saveexec_b64 s[0:1], vcc
    v_mov_b32 v107, 1698959
    v_mul_hi_u32 v107, v107, v27
    v_mul_u32_u24 v107, 2528, v107
    v_sub_u32 v107, v27, v107
    v_lshlrev_b32 v102, 3, v107
    v_add_u32 v102, 127744, v102
    v_lshlrev_b32 v107, 16, v26
    v_and_b32 v103, 0xffff0000, v26
    v_lshlrev_b32 v104, 16, v24
    v_mul_f32 v105, v107, v104
    ds_add_f32 v102, v105 offset:0
    v_mul_f32 v106, v103, v104
    ds_add_f32 v102, v106 offset:4
    v_and_b32 v104, 0xffff0000, v24
    v_mul_f32 v105, v107, v104
    ds_add_f32 v102, v105 offset:8
    v_mul_f32 v106, v103, v104
    ds_add_f32 v102, v106 offset:12
    v_lshlrev_b32 v104, 16, v25
    v_mul_f32 v105, v107, v104
    ds_add_f32 v102, v105 offset:16
    v_mul_f32 v106, v103, v104
    ds_add_f32 v102, v106 offset:20
    v_and_b32 v104, 0xffff0000, v25
    v_mul_f32 v105, v107, v104
    ds_add_f32 v102, v105 offset:24
    v_mul_f32 v106, v103, v104
    ds_add_f32 v102, v106 offset:28
    s_andn2_b64 exec, s[0:1], vcc
    s_branch k2_ovrR4
k2_ovR5:
    s_and_saveexec_b64 s[0:1], vcc
    v_mov_b32 v107, 1698959
    v_mul_hi_u32 v107, v107, v31
    v_mul_u32_u24 v107, 2528, v107
    v_sub_u32 v107, v31, v107
    v_lshlrev_b32 v102, 3, v107
    v_add_u32 v102, 127744, v102
    v_lshlrev_b32 v107, 16, v30
    v_and_b32 v103, 0xffff0000, v30
    v_lshlrev_b32 v104, 16, v28
    v_mul_f32 v105, v107, v104
    ds_add_f32 v102, v105 offset:0
    v_mul_f32 v106, v103, v104
    ds_add_f32 v102, v106 offset:4
    v_and_b32 v104, 0xffff0000, v28
    v_mul_f32 v105, v107, v104
    ds_add_f32 v102, v105 offset:8
    v_mul_f32 v106, v103, v104
    ds_add_f32 v102, v106 offset:12
    v_lshlrev_b32 v104, 16, v29
    v_mul_f32 v105, v107, v104
    ds_add_f32 v102, v105 offset:16
    v_mul_f32 v106, v103, v104
    ds_add_f32 v102, v106 offset:20
    v_and_b32 v104, 0xffff0000, v29
    v_mul_f32 v105, v107, v104
    ds_add_f32 v102, v105 offset:24
    v_mul_f32 v106, v103, v104
    ds_add_f32 v102, v106 offset:28
    s_andn2_b64 exec, s[0:1], vcc
    s_branch k2_ovrR5
k2_ovR6:
    s_and_saveexec_b64 s[0:1], vcc
    v_mov_b32 v107, 1698959
    v_mul_hi_u32 v107, v107, v35
    v_mul_u32_u24 v107, 2528, v107
    v_sub_u32 v107, v35, v107
    v_lshlrev_b32 v102, 3, v107
    v_add_u32 v102, 127744, v102
    v_lshlrev_b32 v107, 16, v34
    v_and_b32 v103, 0xffff0000, v34
    v_lshlrev_b32 v104, 16, v32
    v_mul_f32 v105, v107, v104
    ds_add_f32 v102, v105 offset:0
    v_mul_f32 v106, v103, v104
    ds_add_f32 v102, v106 offset:4
    v_and_b32 v104, 0xffff0000, v32
    v_mul_f32 v105, v107, v104
    ds_add_f32 v102, v105 offset:8
    v_mul_f32 v106, v103, v104
    ds_add_f32 v102, v106 offset:12
    v_lshlrev_b32 v104, 16, v33
    v_mul_f32 v105, v107, v104
    ds_add_f32 v102, v105 offset:16
    v_mul_f32 v106, v103, v104
    ds_add_f32 v102, v106 offset:20
    v_and_b32 v104, 0xffff0000, v33
    v_mul_f32 v105, v107, v104
    ds_add_f32 v102, v105 offset:24
    v_mul_f32 v106, v103, v104
    ds_add_f32 v102, v106 offset:28
    s_andn2_b64 exec, s[0:1], vcc
    s_branch k2_ovrR6
k2_ovR7:
    s_and_saveexec_b64 s[0:1], vcc
    v_mov_b32 v107, 1698959
    v_mul_hi_u32 v107, v107, v39
    v_mul_u32_u24 v107, 2528, v107
    v_sub_u32 v107, v39, v107
    v_lshlrev_b32 v102, 3, v107
    v_add_u32 v102, 127744, v102
    v_lshlrev_b32 v107, 16, v38
    v_and_b32 v103, 0xffff0000, v38
    v_lshlrev_b32 v104, 16, v36
    v_mul_f32 v105, v107, v104
    ds_add_f32 v102, v105 offset:0
    v_mul_f32 v106, v103, v104
    ds_add_f32 v102, v106 offset:4
    v_and_b32 v104, 0xffff0000, v36
    v_mul_f32 v105, v107, v104
    ds_add_f32 v102, v105 offset:8
    v_mul_f32 v106, v103, v104
    ds_add_f32 v102, v106 offset:12
    v_lshlrev_b32 v104, 16, v37
    v_mul_f32 v105, v107, v104
    ds_add_f32 v102, v105 offset:16
    v_mul_f32 v106, v103, v104
    ds_add_f32 v102, v106 offset:20
    v_and_b32 v104, 0xffff0000, v37
    v_mul_f32 v105, v107, v104
    ds_add_f32 v102, v105 offset:24
    v_mul_f32 v106, v103, v104
    ds_add_f32 v102, v106 offset:28
    s_andn2_b64 exec, s[0:1], vcc
    s_branch k2_ovrR7
k2_ovR8:
    s_and_saveexec_b64 s[0:1], vcc
    v_mov_b32 v107, 1698959
    v_mul_hi_u32 v107, v107, v43
    v_mul_u32_u24 v107, 2528, v107
    v_sub_u32 v107, v43, v107
    v_lshlrev_b32 v102, 3, v107
    v_add_u32 v102, 127744, v102
    v_lshlrev_b32 v107, 16, v42
    v_and_b32 v103, 0xffff0000, v42
    v_lshlrev_b32 v104, 16, v40
    v_mul_f32 v105, v107, v104
    ds_add_f32 v102, v105 offset:0
    v_mul_f32 v106, v103, v104
    ds_add_f32 v102, v106 offset:4
    v_and_b32 v104, 0xffff0000, v40
    v_mul_f32 v105, v107, v104
    ds_add_f32 v102, v105 offset:8
    v_mul_f32 v106, v103, v104
    ds_add_f32 v102, v106 offset:12
    v_lshlrev_b32 v104, 16, v41
    v_mul_f32 v105, v107, v104
    ds_add_f32 v102, v105 offset:16
    v_mul_f32 v106, v103, v104
    ds_add_f32 v102, v106 offset:20
    v_and_b32 v104, 0xffff0000, v41
    v_mul_f32 v105, v107, v104
    ds_add_f32 v102, v105 offset:24
    v_mul_f32 v106, v103, v104
    ds_add_f32 v102, v106 offset:28
    s_andn2_b64 exec, s[0:1], vcc
    s_branch k2_ovrR8
k2_ovR9:
    s_and_saveexec_b64 s[0:1], vcc
    v_mov_b32 v107, 1698959
    v_mul_hi_u32 v107, v107, v47
    v_mul_u32_u24 v107, 2528, v107
    v_sub_u32 v107, v47, v107
    v_lshlrev_b32 v102, 3, v107
    v_add_u32 v102, 127744, v102
    v_lshlrev_b32 v107, 16, v46
    v_and_b32 v103, 0xffff0000, v46
    v_lshlrev_b32 v104, 16, v44
    v_mul_f32 v105, v107, v104
    ds_add_f32 v102, v105 offset:0
    v_mul_f32 v106, v103, v104
    ds_add_f32 v102, v106 offset:4
    v_and_b32 v104, 0xffff0000, v44
    v_mul_f32 v105, v107, v104
    ds_add_f32 v102, v105 offset:8
    v_mul_f32 v106, v103, v104
    ds_add_f32 v102, v106 offset:12
    v_lshlrev_b32 v104, 16, v45
    v_mul_f32 v105, v107, v104
    ds_add_f32 v102, v105 offset:16
    v_mul_f32 v106, v103, v104
    ds_add_f32 v102, v106 offset:20
    v_and_b32 v104, 0xffff0000, v45
    v_mul_f32 v105, v107, v104
    ds_add_f32 v102, v105 offset:24
    v_mul_f32 v106, v103, v104
    ds_add_f32 v102, v106 offset:28
    s_andn2_b64 exec, s[0:1], vcc
    s_branch k2_ovrR9
k2_ovR10:
    s_and_saveexec_b64 s[0:1], vcc
    v_mov_b32 v107, 1698959
    v_mul_hi_u32 v107, v107, v51
    v_mul_u32_u24 v107, 2528, v107
    v_sub_u32 v107, v51, v107
    v_lshlrev_b32 v102, 3, v107
    v_add_u32 v102, 127744, v102
    v_lshlrev_b32 v107, 16, v50
    v_and_b32 v103, 0xffff0000, v50
    v_lshlrev_b32 v104, 16, v48
    v_mul_f32 v105, v107, v104
    ds_add_f32 v102, v105 offset:0
    v_mul_f32 v106, v103, v104
    ds_add_f32 v102, v106 offset:4
    v_and_b32 v104, 0xffff0000, v48
    v_mul_f32 v105, v107, v104
    ds_add_f32 v102, v105 offset:8
    v_mul_f32 v106, v103, v104
    ds_add_f32 v102, v106 offset:12
    v_lshlrev_b32 v104, 16, v49
    v_mul_f32 v105, v107, v104
    ds_add_f32 v102, v105 offset:16
    v_mul_f32 v106, v103, v104
    ds_add_f32 v102, v106 offset:20
    v_and_b32 v104, 0xffff0000, v49
    v_mul_f32 v105, v107, v104
    ds_add_f32 v102, v105 offset:24
    v_mul_f32 v106, v103, v104
    ds_add_f32 v102, v106 offset:28
    s_andn2_b64 exec, s[0:1], vcc
    s_branch k2_ovrR10
k2_ovR11:
    s_and_saveexec_b64 s[0:1], vcc
    v_mov_b32 v107, 1698959
    v_mul_hi_u32 v107, v107, v55
    v_mul_u32_u24 v107, 2528, v107
    v_sub_u32 v107, v55, v107
    v_lshlrev_b32 v102, 3, v107
    v_add_u32 v102, 127744, v102
    v_lshlrev_b32 v107, 16, v54
    v_and_b32 v103, 0xffff0000, v54
    v_lshlrev_b32 v104, 16, v52
    v_mul_f32 v105, v107, v104
    ds_add_f32 v102, v105 offset:0
    v_mul_f32 v106, v103, v104
    ds_add_f32 v102, v106 offset:4
    v_and_b32 v104, 0xffff0000, v52
    v_mul_f32 v105, v107, v104
    ds_add_f32 v102, v105 offset:8
    v_mul_f32 v106, v103, v104
    ds_add_f32 v102, v106 offset:12
    v_lshlrev_b32 v104, 16, v53
    v_mul_f32 v105, v107, v104
    ds_add_f32 v102, v105 offset:16
    v_mul_f32 v106, v103, v104
    ds_add_f32 v102, v106 offset:20
    v_and_b32 v104, 0xffff0000, v53
    v_mul_f32 v105, v107, v104
    ds_add_f32 v102, v105 offset:24
    v_mul_f32 v106, v103, v104
    ds_add_f32 v102, v106 offset:28
    s_andn2_b64 exec, s[0:1], vcc
    s_branch k2_ovrR11
k2_ovR12:
    s_and_saveexec_b64 s[0:1], vcc
    v_mov_b32 v107, 1698959
    v_mul_hi_u32 v107, v107, v59
    v_mul_u32_u24 v107, 2528, v107
    v_sub_u32 v107, v59, v107
    v_lshlrev_b32 v102, 3, v107
    v_add_u32 v102, 127744, v102
    v_lshlrev_b32 v107, 16, v58
    v_and_b32 v103, 0xffff0000, v58
    v_lshlrev_b32 v104, 16, v56
    v_mul_f32 v105, v107, v104
    ds_add_f32 v102, v105 offset:0
    v_mul_f32 v106, v103, v104
    ds_add_f32 v102, v106 offset:4
    v_and_b32 v104, 0xffff0000, v56
    v_mul_f32 v105, v107, v104
    ds_add_f32 v102, v105 offset:8
    v_mul_f32 v106, v103, v104
    ds_add_f32 v102, v106 offset:12
    v_lshlrev_b32 v104, 16, v57
    v_mul_f32 v105, v107, v104
    ds_add_f32 v102, v105 offset:16
    v_mul_f32 v106, v103, v104
    ds_add_f32 v102, v106 offset:20
    v_and_b32 v104, 0xffff0000, v57
    v_mul_f32 v105, v107, v104
    ds_add_f32 v102, v105 offset:24
    v_mul_f32 v106, v103, v104
    ds_add_f32 v102, v106 offset:28
    s_andn2_b64 exec, s[0:1], vcc
    s_branch k2_ovrR12
k2_ovR13:
    s_and_saveexec_b64 s[0:1], vcc
    v_mov_b32 v107, 1698959
    v_mul_hi_u32 v107, v107, v63
    v_mul_u32_u24 v107, 2528, v107
    v_sub_u32 v107, v63, v107
    v_lshlrev_b32 v102, 3, v107
    v_add_u32 v102, 127744, v102
    v_lshlrev_b32 v107, 16, v62
    v_and_b32 v103, 0xffff0000, v62
    v_lshlrev_b32 v104, 16, v60
    v_mul_f32 v105, v107, v104
    ds_add_f32 v102, v105 offset:0
    v_mul_f32 v106, v103, v104
    ds_add_f32 v102, v106 offset:4
    v_and_b32 v104, 0xffff0000, v60
    v_mul_f32 v105, v107, v104
    ds_add_f32 v102, v105 offset:8
    v_mul_f32 v106, v103, v104
    ds_add_f32 v102, v106 offset:12
    v_lshlrev_b32 v104, 16, v61
    v_mul_f32 v105, v107, v104
    ds_add_f32 v102, v105 offset:16
    v_mul_f32 v106, v103, v104
    ds_add_f32 v102, v106 offset:20
    v_and_b32 v104, 0xffff0000, v61
    v_mul_f32 v105, v107, v104
    ds_add_f32 v102, v105 offset:24
    v_mul_f32 v106, v103, v104
    ds_add_f32 v102, v106 offset:28
    s_andn2_b64 exec, s[0:1], vcc
    s_branch k2_ovrR13
k2_ovR14:
    s_and_saveexec_b64 s[0:1], vcc
    v_mov_b32 v107, 1698959
    v_mul_hi_u32 v107, v107, v67
    v_mul_u32_u24 v107, 2528, v107
    v_sub_u32 v107, v67, v107
    v_lshlrev_b32 v102, 3, v107
    v_add_u32 v102, 127744, v102
    v_lshlrev_b32 v107, 16, v66
    v_and_b32 v103, 0xffff0000, v66
    v_lshlrev_b32 v104, 16, v64
    v_mul_f32 v105, v107, v104
    ds_add_f32 v102, v105 offset:0
    v_mul_f32 v106, v103, v104
    ds_add_f32 v102, v106 offset:4
    v_and_b32 v104, 0xffff0000, v64
    v_mul_f32 v105, v107, v104
    ds_add_f32 v102, v105 offset:8
    v_mul_f32 v106, v103, v104
    ds_add_f32 v102, v106 offset:12
    v_lshlrev_b32 v104, 16, v65
    v_mul_f32 v105, v107, v104
    ds_add_f32 v102, v105 offset:16
    v_mul_f32 v106, v103, v104
    ds_add_f32 v102, v106 offset:20
    v_and_b32 v104, 0xffff0000, v65
    v_mul_f32 v105, v107, v104
    ds_add_f32 v102, v105 offset:24
    v_mul_f32 v106, v103, v104
    ds_add_f32 v102, v106 offset:28
    s_andn2_b64 exec, s[0:1], vcc
    s_branch k2_ovrR14
k2_ovR15:
    s_and_saveexec_b64 s[0:1], vcc
    v_mov_b32 v107, 1698959
    v_mul_hi_u32 v107, v107, v71
    v_mul_u32_u24 v107, 2528, v107
    v_sub_u32 v107, v71, v107
    v_lshlrev_b32 v102, 3, v107
    v_add_u32 v102, 127744, v102
    v_lshlrev_b32 v107, 16, v70
    v_and_b32 v103, 0xffff0000, v70
    v_lshlrev_b32 v104, 16, v68
    v_mul_f32 v105, v107, v104
    ds_add_f32 v102, v105 offset:0
    v_mul_f32 v106, v103, v104
    ds_add_f32 v102, v106 offset:4
    v_and_b32 v104, 0xffff0000, v68
    v_mul_f32 v105, v107, v104
    ds_add_f32 v102, v105 offset:8
    v_mul_f32 v106, v103, v104
    ds_add_f32 v102, v106 offset:12
    v_lshlrev_b32 v104, 16, v69
    v_mul_f32 v105, v107, v104
    ds_add_f32 v102, v105 offset:16
    v_mul_f32 v106, v103, v104
    ds_add_f32 v102, v106 offset:20
    v_and_b32 v104, 0xffff0000, v69
    v_mul_f32 v105, v107, v104
    ds_add_f32 v102, v105 offset:24
    v_mul_f32 v106, v103, v104
    ds_add_f32 v102, v106 offset:28
    s_andn2_b64 exec, s[0:1], vcc
    s_branch k2_ovrR15
k2_pwaitN:
    s_mov_b64 exec, vcc
    s_sub_u32 s81, s81, 1
    s_cbranch_scc1 k2_end
    s_sleep 4
    buffer_load_dword v101, v24, s[4:7], s79 offen sc1
    s_waitcnt vmcnt(0)
    v_cmp_eq_u32 vcc, 0, v101
    s_cbranch_vccnz k2_pwaitN
    s_mov_b64 exec, 0xffff
    s_branch k2_pokN
k2_leftN:
    s_mov_b64 s[36:37], vcc
k2_ljN:
    s_ff1_i32_b64 s38, s[36:37]
    s_bitset0_b64 s[36:37], s38
    v_readlane_b32 s39, v100, s38
    v_readlane_b32 s40, v101, s38
    s_nop 4
    s_sub_u32 s40, s40, 63
k2_lcN:
    s_add_u32 s39, s39, 252
    s_lshr_b32 s41, s39, 2
    s_min_u32 s42, s40, 63
    s_bfm_b64 exec, s42, 0
    buffer_load_dword v113, v1, s[4:7], s39 offen sc1
    buffer_load_ubyte v114, v2, s[4:7], s41 offen sc1
    s_waitcnt vmcnt(0)
    v_lshlrev_b32 v114, 2, v114
    v_lshrrev_b32 v107, 7, v113
    v_and_b32 v107, 0x1ff8, v107
    v_mul_u32_u24 v108, 1250, v114
    v_add_u32 v107, v107, v108
    buffer_load_dwordx2 v[110:111], v107, s[8:11], 0 offen
    v_cvt_f32_i32 v112, v113
    v_mul_f32 v112, 0x30002008, v112
    v_fma_f32 v108, v112, v112, -0.5
    v_cvt_pk_bf16_f32 v112, v112, v108
    v_and_b32 v107, 0x3ff, v113
    v_lshlrev_b32 v107, 2, v107
    s_waitcnt vmcnt(0)
    v_lshlrev_b32 v102, 3, v107
    v_add_u32 v102, 127744, v102
    v_lshlrev_b32 v107, 16, v112
    v_and_b32 v103, 0xffff0000, v112
    v_lshlrev_b32 v104, 16, v110
    v_mul_f32 v105, v107, v104
    ds_add_f32 v102, v105 offset:0
    v_mul_f32 v106, v103, v104
    ds_add_f32 v102, v106 offset:4
    v_and_b32 v104, 0xffff0000, v110
    v_mul_f32 v105, v107, v104
    ds_add_f32 v102, v105 offset:8
    v_mul_f32 v106, v103, v104
    ds_add_f32 v102, v106 offset:12
    v_lshlrev_b32 v104, 16, v111
    v_mul_f32 v105, v107, v104
    ds_add_f32 v102, v105 offset:16
    v_mul_f32 v106, v103, v104
    ds_add_f32 v102, v106 offset:20
    v_and_b32 v104, 0xffff0000, v111
    v_mul_f32 v105, v107, v104
    ds_add_f32 v102, v105 offset:24
    v_mul_f32 v106, v103, v104
    ds_add_f32 v102, v106 offset:28
    s_sub_u32 s40, s40, s42
    s_cmp_lg_u32 s40, 0
    s_cbranch_scc1 k2_lcN
    s_cmp_lg_u64 s[36:37], 0
    s_cbranch_scc1 k2_ljN
    s_branch k2_leftrN
k2_soN0:
    s_and_saveexec_b64 s[0:1], vcc
    v_lshrrev_b32 v107, 7, v10
    v_and_b32 v107, 0x1ff8, v107
    v_mul_u32_u24 v108, 1250, v11
    v_add_u32 v107, v107, v108
    buffer_load_dwordx2 v[110:111], v107, s[8:11], 0 offen
    v_cvt_f32_i32 v112, v10
    v_mul_f32 v112, 0x30002008, v112
    v_fma_f32 v108, v112, v112, -0.5
    v_cvt_pk_bf16_f32 v112, v112, v108
    v_and_b32 v107, 0x3ff, v10
    v_lshlrev_b32 v107, 2, v107
    s_waitcnt vmcnt(0)
    v_lshlrev_b32 v102, 3, v107
    v_add_u32 v102, 127744, v102
    v_lshlrev_b32 v107, 16, v112
    v_and_b32 v103, 0xffff0000, v112
    v_lshlrev_b32 v104, 16, v110
    v_mul_f32 v105, v107, v104
    ds_add_f32 v102, v105 offset:0
    v_mul_f32 v106, v103, v104
    ds_add_f32 v102, v106 offset:4
    v_and_b32 v104, 0xffff0000, v110
    v_mul_f32 v105, v107, v104
    ds_add_f32 v102, v105 offset:8
    v_mul_f32 v106, v103, v104
    ds_add_f32 v102, v106 offset:12
    v_lshlrev_b32 v104, 16, v111
    v_mul_f32 v105, v107, v104
    ds_add_f32 v102, v105 offset:16
    v_mul_f32 v106, v103, v104
    ds_add_f32 v102, v106 offset:20
    v_and_b32 v104, 0xffff0000, v111
    v_mul_f32 v105, v107, v104
    ds_add_f32 v102, v105 offset:24
    v_mul_f32 v106, v103, v104
    ds_add_f32 v102, v106 offset:28
    s_andn2_b64 exec, s[0:1], vcc
    s_branch k2_sorN0
k2_soN1:
    s_and_saveexec_b64 s[0:1], vcc
    v_lshrrev_b32 v107, 7, v14
    v_and_b32 v107, 0x1ff8, v107
    v_mul_u32_u24 v108, 1250, v15
    v_add_u32 v107, v107, v108
    buffer_load_dwordx2 v[110:111], v107, s[8:11], 0 offen
    v_cvt_f32_i32 v112, v14
    v_mul_f32 v112, 0x30002008, v112
    v_fma_f32 v108, v112, v112, -0.5
    v_cvt_pk_bf16_f32 v112, v112, v108
    v_and_b32 v107, 0x3ff, v14
    v_lshlrev_b32 v107, 2, v107
    s_waitcnt vmcnt(0)
    v_lshlrev_b32 v102, 3, v107
    v_add_u32 v102, 127744, v102
    v_lshlrev_b32 v107, 16, v112
    v_and_b32 v103, 0xffff0000, v112
    v_lshlrev_b32 v104, 16, v110
    v_mul_f32 v105, v107, v104
    ds_add_f32 v102, v105 offset:0
    v_mul_f32 v106, v103, v104
    ds_add_f32 v102, v106 offset:4
    v_and_b32 v104, 0xffff0000, v110
    v_mul_f32 v105, v107, v104
    ds_add_f32 v102, v105 offset:8
    v_mul_f32 v106, v103, v104
    ds_add_f32 v102, v106 offset:12
    v_lshlrev_b32 v104, 16, v111
    v_mul_f32 v105, v107, v104
    ds_add_f32 v102, v105 offset:16
    v_mul_f32 v106, v103, v104
    ds_add_f32 v102, v106 offset:20
    v_and_b32 v104, 0xffff0000, v111
    v_mul_f32 v105, v107, v104
    ds_add_f32 v102, v105 offset:24
    v_mul_f32 v106, v103, v104
    ds_add_f32 v102, v106 offset:28
    s_andn2_b64 exec, s[0:1], vcc
    s_branch k2_sorN1
k2_soN2:
    s_and_saveexec_b64 s[0:1], vcc
    v_lshrrev_b32 v107, 7, v18
    v_and_b32 v107, 0x1ff8, v107
    v_mul_u32_u24 v108, 1250, v19
    v_add_u32 v107, v107, v108
    buffer_load_dwordx2 v[110:111], v107, s[8:11], 0 offen
    v_cvt_f32_i32 v112, v18
    v_mul_f32 v112, 0x30002008, v112
    v_fma_f32 v108, v112, v112, -0.5
    v_cvt_pk_bf16_f32 v112, v112, v108
    v_and_b32 v107, 0x3ff, v18
    v_lshlrev_b32 v107, 2, v107
    s_waitcnt vmcnt(0)
    v_lshlrev_b32 v102, 3, v107
    v_add_u32 v102, 127744, v102
    v_lshlrev_b32 v107, 16, v112
    v_and_b32 v103, 0xffff0000, v112
    v_lshlrev_b32 v104, 16, v110
    v_mul_f32 v105, v107, v104
    ds_add_f32 v102, v105 offset:0
    v_mul_f32 v106, v103, v104
    ds_add_f32 v102, v106 offset:4
    v_and_b32 v104, 0xffff0000, v110
    v_mul_f32 v105, v107, v104
    ds_add_f32 v102, v105 offset:8
    v_mul_f32 v106, v103, v104
    ds_add_f32 v102, v106 offset:12
    v_lshlrev_b32 v104, 16, v111
    v_mul_f32 v105, v107, v104
    ds_add_f32 v102, v105 offset:16
    v_mul_f32 v106, v103, v104
    ds_add_f32 v102, v106 offset:20
    v_and_b32 v104, 0xffff0000, v111
    v_mul_f32 v105, v107, v104
    ds_add_f32 v102, v105 offset:24
    v_mul_f32 v106, v103, v104
    ds_add_f32 v102, v106 offset:28
    s_andn2_b64 exec, s[0:1], vcc
    s_branch k2_sorN2
k2_soN3:
    s_and_saveexec_b64 s[0:1], vcc
    v_lshrrev_b32 v107, 7, v22
    v_and_b32 v107, 0x1ff8, v107
    v_mul_u32_u24 v108, 1250, v23
    v_add_u32 v107, v107, v108
    buffer_load_dwordx2 v[110:111], v107, s[8:11], 0 offen
    v_cvt_f32_i32 v112, v22
    v_mul_f32 v112, 0x30002008, v112
    v_fma_f32 v108, v112, v112, -0.5
    v_cvt_pk_bf16_f32 v112, v112, v108
    v_and_b32 v107, 0x3ff, v22
    v_lshlrev_b32 v107, 2, v107
    s_waitcnt vmcnt(0)
    v_lshlrev_b32 v102, 3, v107
    v_add_u32 v102, 127744, v102
    v_lshlrev_b32 v107, 16, v112
    v_and_b32 v103, 0xffff0000, v112
    v_lshlrev_b32 v104, 16, v110
    v_mul_f32 v105, v107, v104
    ds_add_f32 v102, v105 offset:0
    v_mul_f32 v106, v103, v104
    ds_add_f32 v102, v106 offset:4
    v_and_b32 v104, 0xffff0000, v110
    v_mul_f32 v105, v107, v104
    ds_add_f32 v102, v105 offset:8
    v_mul_f32 v106, v103, v104
    ds_add_f32 v102, v106 offset:12
    v_lshlrev_b32 v104, 16, v111
    v_mul_f32 v105, v107, v104
    ds_add_f32 v102, v105 offset:16
    v_mul_f32 v106, v103, v104
    ds_add_f32 v102, v106 offset:20
    v_and_b32 v104, 0xffff0000, v111
    v_mul_f32 v105, v107, v104
    ds_add_f32 v102, v105 offset:24
    v_mul_f32 v106, v103, v104
    ds_add_f32 v102, v106 offset:28
    s_andn2_b64 exec, s[0:1], vcc
    s_branch k2_sorN3
k2_soN4:
    s_and_saveexec_b64 s[0:1], vcc
    v_lshrrev_b32 v107, 7, v26
    v_and_b32 v107, 0x1ff8, v107
    v_mul_u32_u24 v108, 1250, v27
    v_add_u32 v107, v107, v108
    buffer_load_dwordx2 v[110:111], v107, s[8:11], 0 offen
    v_cvt_f32_i32 v112, v26
    v_mul_f32 v112, 0x30002008, v112
    v_fma_f32 v108, v112, v112, -0.5
    v_cvt_pk_bf16_f32 v112, v112, v108
    v_and_b32 v107, 0x3ff, v26
    v_lshlrev_b32 v107, 2, v107
    s_waitcnt vmcnt(0)
    v_lshlrev_b32 v102, 3, v107
    v_add_u32 v102, 127744, v102
    v_lshlrev_b32 v107, 16, v112
    v_and_b32 v103, 0xffff0000, v112
    v_lshlrev_b32 v104, 16, v110
    v_mul_f32 v105, v107, v104
    ds_add_f32 v102, v105 offset:0
    v_mul_f32 v106, v103, v104
    ds_add_f32 v102, v106 offset:4
    v_and_b32 v104, 0xffff0000, v110
    v_mul_f32 v105, v107, v104
    ds_add_f32 v102, v105 offset:8
    v_mul_f32 v106, v103, v104
    ds_add_f32 v102, v106 offset:12
    v_lshlrev_b32 v104, 16, v111
    v_mul_f32 v105, v107, v104
    ds_add_f32 v102, v105 offset:16
    v_mul_f32 v106, v103, v104
    ds_add_f32 v102, v106 offset:20
    v_and_b32 v104, 0xffff0000, v111
    v_mul_f32 v105, v107, v104
    ds_add_f32 v102, v105 offset:24
    v_mul_f32 v106, v103, v104
    ds_add_f32 v102, v106 offset:28
    s_andn2_b64 exec, s[0:1], vcc
    s_branch k2_sorN4
k2_soN5:
    s_and_saveexec_b64 s[0:1], vcc
    v_lshrrev_b32 v107, 7, v30
    v_and_b32 v107, 0x1ff8, v107
    v_mul_u32_u24 v108, 1250, v31
    v_add_u32 v107, v107, v108
    buffer_load_dwordx2 v[110:111], v107, s[8:11], 0 offen
    v_cvt_f32_i32 v112, v30
    v_mul_f32 v112, 0x30002008, v112
    v_fma_f32 v108, v112, v112, -0.5
    v_cvt_pk_bf16_f32 v112, v112, v108
    v_and_b32 v107, 0x3ff, v30
    v_lshlrev_b32 v107, 2, v107
    s_waitcnt vmcnt(0)
    v_lshlrev_b32 v102, 3, v107
    v_add_u32 v102, 127744, v102
    v_lshlrev_b32 v107, 16, v112
    v_and_b32 v103, 0xffff0000, v112
    v_lshlrev_b32 v104, 16, v110
    v_mul_f32 v105, v107, v104
    ds_add_f32 v102, v105 offset:0
    v_mul_f32 v106, v103, v104
    ds_add_f32 v102, v106 offset:4
    v_and_b32 v104, 0xffff0000, v110
    v_mul_f32 v105, v107, v104
    ds_add_f32 v102, v105 offset:8
    v_mul_f32 v106, v103, v104
    ds_add_f32 v102, v106 offset:12
    v_lshlrev_b32 v104, 16, v111
    v_mul_f32 v105, v107, v104
    ds_add_f32 v102, v105 offset:16
    v_mul_f32 v106, v103, v104
    ds_add_f32 v102, v106 offset:20
    v_and_b32 v104, 0xffff0000, v111
    v_mul_f32 v105, v107, v104
    ds_add_f32 v102, v105 offset:24
    v_mul_f32 v106, v103, v104
    ds_add_f32 v102, v106 offset:28
    s_andn2_b64 exec, s[0:1], vcc
    s_branch k2_sorN5
k2_soN6:
    s_and_saveexec_b64 s[0:1], vcc
    v_lshrrev_b32 v107, 7, v34
    v_and_b32 v107, 0x1ff8, v107
    v_mul_u32_u24 v108, 1250, v35
    v_add_u32 v107, v107, v108
    buffer_load_dwordx2 v[110:111], v107, s[8:11], 0 offen
    v_cvt_f32_i32 v112, v34
    v_mul_f32 v112, 0x30002008, v112
    v_fma_f32 v108, v112, v112, -0.5
    v_cvt_pk_bf16_f32 v112, v112, v108
    v_and_b32 v107, 0x3ff, v34
    v_lshlrev_b32 v107, 2, v107
    s_waitcnt vmcnt(0)
    v_lshlrev_b32 v102, 3, v107
    v_add_u32 v102, 127744, v102
    v_lshlrev_b32 v107, 16, v112
    v_and_b32 v103, 0xffff0000, v112
    v_lshlrev_b32 v104, 16, v110
    v_mul_f32 v105, v107, v104
    ds_add_f32 v102, v105 offset:0
    v_mul_f32 v106, v103, v104
    ds_add_f32 v102, v106 offset:4
    v_and_b32 v104, 0xffff0000, v110
    v_mul_f32 v105, v107, v104
    ds_add_f32 v102, v105 offset:8
    v_mul_f32 v106, v103, v104
    ds_add_f32 v102, v106 offset:12
    v_lshlrev_b32 v104, 16, v111
    v_mul_f32 v105, v107, v104
    ds_add_f32 v102, v105 offset:16
    v_mul_f32 v106, v103, v104
    ds_add_f32 v102, v106 offset:20
    v_and_b32 v104, 0xffff0000, v111
    v_mul_f32 v105, v107, v104
    ds_add_f32 v102, v105 offset:24
    v_mul_f32 v106, v103, v104
    ds_add_f32 v102, v106 offset:28
    s_andn2_b64 exec, s[0:1], vcc
    s_branch k2_sorN6
k2_soN7:
    s_and_saveexec_b64 s[0:1], vcc
    v_lshrrev_b32 v107, 7, v38
    v_and_b32 v107, 0x1ff8, v107
    v_mul_u32_u24 v108, 1250, v39
    v_add_u32 v107, v107, v108
    buffer_load_dwordx2 v[110:111], v107, s[8:11], 0 offen
    v_cvt_f32_i32 v112, v38
    v_mul_f32 v112, 0x30002008, v112
    v_fma_f32 v108, v112, v112, -0.5
    v_cvt_pk_bf16_f32 v112, v112, v108
    v_and_b32 v107, 0x3ff, v38
    v_lshlrev_b32 v107, 2, v107
    s_waitcnt vmcnt(0)
    v_lshlrev_b32 v102, 3, v107
    v_add_u32 v102, 127744, v102
    v_lshlrev_b32 v107, 16, v112
    v_and_b32 v103, 0xffff0000, v112
    v_lshlrev_b32 v104, 16, v110
    v_mul_f32 v105, v107, v104
    ds_add_f32 v102, v105 offset:0
    v_mul_f32 v106, v103, v104
    ds_add_f32 v102, v106 offset:4
    v_and_b32 v104, 0xffff0000, v110
    v_mul_f32 v105, v107, v104
    ds_add_f32 v102, v105 offset:8
    v_mul_f32 v106, v103, v104
    ds_add_f32 v102, v106 offset:12
    v_lshlrev_b32 v104, 16, v111
    v_mul_f32 v105, v107, v104
    ds_add_f32 v102, v105 offset:16
    v_mul_f32 v106, v103, v104
    ds_add_f32 v102, v106 offset:20
    v_and_b32 v104, 0xffff0000, v111
    v_mul_f32 v105, v107, v104
    ds_add_f32 v102, v105 offset:24
    v_mul_f32 v106, v103, v104
    ds_add_f32 v102, v106 offset:28
    s_andn2_b64 exec, s[0:1], vcc
    s_branch k2_sorN7
k2_soN8:
    s_and_saveexec_b64 s[0:1], vcc
    v_lshrrev_b32 v107, 7, v42
    v_and_b32 v107, 0x1ff8, v107
    v_mul_u32_u24 v108, 1250, v43
    v_add_u32 v107, v107, v108
    buffer_load_dwordx2 v[110:111], v107, s[8:11], 0 offen
    v_cvt_f32_i32 v112, v42
    v_mul_f32 v112, 0x30002008, v112
    v_fma_f32 v108, v112, v112, -0.5
    v_cvt_pk_bf16_f32 v112, v112, v108
    v_and_b32 v107, 0x3ff, v42
    v_lshlrev_b32 v107, 2, v107
    s_waitcnt vmcnt(0)
    v_lshlrev_b32 v102, 3, v107
    v_add_u32 v102, 127744, v102
    v_lshlrev_b32 v107, 16, v112
    v_and_b32 v103, 0xffff0000, v112
    v_lshlrev_b32 v104, 16, v110
    v_mul_f32 v105, v107, v104
    ds_add_f32 v102, v105 offset:0
    v_mul_f32 v106, v103, v104
    ds_add_f32 v102, v106 offset:4
    v_and_b32 v104, 0xffff0000, v110
    v_mul_f32 v105, v107, v104
    ds_add_f32 v102, v105 offset:8
    v_mul_f32 v106, v103, v104
    ds_add_f32 v102, v106 offset:12
    v_lshlrev_b32 v104, 16, v111
    v_mul_f32 v105, v107, v104
    ds_add_f32 v102, v105 offset:16
    v_mul_f32 v106, v103, v104
    ds_add_f32 v102, v106 offset:20
    v_and_b32 v104, 0xffff0000, v111
    v_mul_f32 v105, v107, v104
    ds_add_f32 v102, v105 offset:24
    v_mul_f32 v106, v103, v104
    ds_add_f32 v102, v106 offset:28
    s_andn2_b64 exec, s[0:1], vcc
    s_branch k2_sorN8
k2_soN9:
    s_and_saveexec_b64 s[0:1], vcc
    v_lshrrev_b32 v107, 7, v46
    v_and_b32 v107, 0x1ff8, v107
    v_mul_u32_u24 v108, 1250, v47
    v_add_u32 v107, v107, v108
    buffer_load_dwordx2 v[110:111], v107, s[8:11], 0 offen
    v_cvt_f32_i32 v112, v46
    v_mul_f32 v112, 0x30002008, v112
    v_fma_f32 v108, v112, v112, -0.5
    v_cvt_pk_bf16_f32 v112, v112, v108
    v_and_b32 v107, 0x3ff, v46
    v_lshlrev_b32 v107, 2, v107
    s_waitcnt vmcnt(0)
    v_lshlrev_b32 v102, 3, v107
    v_add_u32 v102, 127744, v102
    v_lshlrev_b32 v107, 16, v112
    v_and_b32 v103, 0xffff0000, v112
    v_lshlrev_b32 v104, 16, v110
    v_mul_f32 v105, v107, v104
    ds_add_f32 v102, v105 offset:0
    v_mul_f32 v106, v103, v104
    ds_add_f32 v102, v106 offset:4
    v_and_b32 v104, 0xffff0000, v110
    v_mul_f32 v105, v107, v104
    ds_add_f32 v102, v105 offset:8
    v_mul_f32 v106, v103, v104
    ds_add_f32 v102, v106 offset:12
    v_lshlrev_b32 v104, 16, v111
    v_mul_f32 v105, v107, v104
    ds_add_f32 v102, v105 offset:16
    v_mul_f32 v106, v103, v104
    ds_add_f32 v102, v106 offset:20
    v_and_b32 v104, 0xffff0000, v111
    v_mul_f32 v105, v107, v104
    ds_add_f32 v102, v105 offset:24
    v_mul_f32 v106, v103, v104
    ds_add_f32 v102, v106 offset:28
    s_andn2_b64 exec, s[0:1], vcc
    s_branch k2_sorN9
k2_soN10:
    s_and_saveexec_b64 s[0:1], vcc
    v_lshrrev_b32 v107, 7, v50
    v_and_b32 v107, 0x1ff8, v107
    v_mul_u32_u24 v108, 1250, v51
    v_add_u32 v107, v107, v108
    buffer_load_dwordx2 v[110:111], v107, s[8:11], 0 offen
    v_cvt_f32_i32 v112, v50
    v_mul_f32 v112, 0x30002008, v112
    v_fma_f32 v108, v112, v112, -0.5
    v_cvt_pk_bf16_f32 v112, v112, v108
    v_and_b32 v107, 0x3ff, v50
    v_lshlrev_b32 v107, 2, v107
    s_waitcnt vmcnt(0)
    v_lshlrev_b32 v102, 3, v107
    v_add_u32 v102, 127744, v102
    v_lshlrev_b32 v107, 16, v112
    v_and_b32 v103, 0xffff0000, v112
    v_lshlrev_b32 v104, 16, v110
    v_mul_f32 v105, v107, v104
    ds_add_f32 v102, v105 offset:0
    v_mul_f32 v106, v103, v104
    ds_add_f32 v102, v106 offset:4
    v_and_b32 v104, 0xffff0000, v110
    v_mul_f32 v105, v107, v104
    ds_add_f32 v102, v105 offset:8
    v_mul_f32 v106, v103, v104
    ds_add_f32 v102, v106 offset:12
    v_lshlrev_b32 v104, 16, v111
    v_mul_f32 v105, v107, v104
    ds_add_f32 v102, v105 offset:16
    v_mul_f32 v106, v103, v104
    ds_add_f32 v102, v106 offset:20
    v_and_b32 v104, 0xffff0000, v111
    v_mul_f32 v105, v107, v104
    ds_add_f32 v102, v105 offset:24
    v_mul_f32 v106, v103, v104
    ds_add_f32 v102, v106 offset:28
    s_andn2_b64 exec, s[0:1], vcc
    s_branch k2_sorN10
k2_soN11:
    s_and_saveexec_b64 s[0:1], vcc
    v_lshrrev_b32 v107, 7, v54
    v_and_b32 v107, 0x1ff8, v107
    v_mul_u32_u24 v108, 1250, v55
    v_add_u32 v107, v107, v108
    buffer_load_dwordx2 v[110:111], v107, s[8:11], 0 offen
    v_cvt_f32_i32 v112, v54
    v_mul_f32 v112, 0x30002008, v112
    v_fma_f32 v108, v112, v112, -0.5
    v_cvt_pk_bf16_f32 v112, v112, v108
    v_and_b32 v107, 0x3ff, v54
    v_lshlrev_b32 v107, 2, v107
    s_waitcnt vmcnt(0)
    v_lshlrev_b32 v102, 3, v107
    v_add_u32 v102, 127744, v102
    v_lshlrev_b32 v107, 16, v112
    v_and_b32 v103, 0xffff0000, v112
    v_lshlrev_b32 v104, 16, v110
    v_mul_f32 v105, v107, v104
    ds_add_f32 v102, v105 offset:0
    v_mul_f32 v106, v103, v104
    ds_add_f32 v102, v106 offset:4
    v_and_b32 v104, 0xffff0000, v110
    v_mul_f32 v105, v107, v104
    ds_add_f32 v102, v105 offset:8
    v_mul_f32 v106, v103, v104
    ds_add_f32 v102, v106 offset:12
    v_lshlrev_b32 v104, 16, v111
    v_mul_f32 v105, v107, v104
    ds_add_f32 v102, v105 offset:16
    v_mul_f32 v106, v103, v104
    ds_add_f32 v102, v106 offset:20
    v_and_b32 v104, 0xffff0000, v111
    v_mul_f32 v105, v107, v104
    ds_add_f32 v102, v105 offset:24
    v_mul_f32 v106, v103, v104
    ds_add_f32 v102, v106 offset:28
    s_andn2_b64 exec, s[0:1], vcc
    s_branch k2_sorN11
k2_soN12:
    s_and_saveexec_b64 s[0:1], vcc
    v_lshrrev_b32 v107, 7, v58
    v_and_b32 v107, 0x1ff8, v107
    v_mul_u32_u24 v108, 1250, v59
    v_add_u32 v107, v107, v108
    buffer_load_dwordx2 v[110:111], v107, s[8:11], 0 offen
    v_cvt_f32_i32 v112, v58
    v_mul_f32 v112, 0x30002008, v112
    v_fma_f32 v108, v112, v112, -0.5
    v_cvt_pk_bf16_f32 v112, v112, v108
    v_and_b32 v107, 0x3ff, v58
    v_lshlrev_b32 v107, 2, v107
    s_waitcnt vmcnt(0)
    v_lshlrev_b32 v102, 3, v107
    v_add_u32 v102, 127744, v102
    v_lshlrev_b32 v107, 16, v112
    v_and_b32 v103, 0xffff0000, v112
    v_lshlrev_b32 v104, 16, v110
    v_mul_f32 v105, v107, v104
    ds_add_f32 v102, v105 offset:0
    v_mul_f32 v106, v103, v104
    ds_add_f32 v102, v106 offset:4
    v_and_b32 v104, 0xffff0000, v110
    v_mul_f32 v105, v107, v104
    ds_add_f32 v102, v105 offset:8
    v_mul_f32 v106, v103, v104
    ds_add_f32 v102, v106 offset:12
    v_lshlrev_b32 v104, 16, v111
    v_mul_f32 v105, v107, v104
    ds_add_f32 v102, v105 offset:16
    v_mul_f32 v106, v103, v104
    ds_add_f32 v102, v106 offset:20
    v_and_b32 v104, 0xffff0000, v111
    v_mul_f32 v105, v107, v104
    ds_add_f32 v102, v105 offset:24
    v_mul_f32 v106, v103, v104
    ds_add_f32 v102, v106 offset:28
    s_andn2_b64 exec, s[0:1], vcc
    s_branch k2_sorN12
k2_soN13:
    s_and_saveexec_b64 s[0:1], vcc
    v_lshrrev_b32 v107, 7, v62
    v_and_b32 v107, 0x1ff8, v107
    v_mul_u32_u24 v108, 1250, v63
    v_add_u32 v107, v107, v108
    buffer_load_dwordx2 v[110:111], v107, s[8:11], 0 offen
    v_cvt_f32_i32 v112, v62
    v_mul_f32 v112, 0x30002008, v112
    v_fma_f32 v108, v112, v112, -0.5
    v_cvt_pk_bf16_f32 v112, v112, v108
    v_and_b32 v107, 0x3ff, v62
    v_lshlrev_b32 v107, 2, v107
    s_waitcnt vmcnt(0)
    v_lshlrev_b32 v102, 3, v107
    v_add_u32 v102, 127744, v102
    v_lshlrev_b32 v107, 16, v112
    v_and_b32 v103, 0xffff0000, v112
    v_lshlrev_b32 v104, 16, v110
    v_mul_f32 v105, v107, v104
    ds_add_f32 v102, v105 offset:0
    v_mul_f32 v106, v103, v104
    ds_add_f32 v102, v106 offset:4
    v_and_b32 v104, 0xffff0000, v110
    v_mul_f32 v105, v107, v104
    ds_add_f32 v102, v105 offset:8
    v_mul_f32 v106, v103, v104
    ds_add_f32 v102, v106 offset:12
    v_lshlrev_b32 v104, 16, v111
    v_mul_f32 v105, v107, v104
    ds_add_f32 v102, v105 offset:16
    v_mul_f32 v106, v103, v104
    ds_add_f32 v102, v106 offset:20
    v_and_b32 v104, 0xffff0000, v111
    v_mul_f32 v105, v107, v104
    ds_add_f32 v102, v105 offset:24
    v_mul_f32 v106, v103, v104
    ds_add_f32 v102, v106 offset:28
    s_andn2_b64 exec, s[0:1], vcc
    s_branch k2_sorN13
k2_soN14:
    s_and_saveexec_b64 s[0:1], vcc
    v_lshrrev_b32 v107, 7, v66
    v_and_b32 v107, 0x1ff8, v107
    v_mul_u32_u24 v108, 1250, v67
    v_add_u32 v107, v107, v108
    buffer_load_dwordx2 v[110:111], v107, s[8:11], 0 offen
    v_cvt_f32_i32 v112, v66
    v_mul_f32 v112, 0x30002008, v112
    v_fma_f32 v108, v112, v112, -0.5
    v_cvt_pk_bf16_f32 v112, v112, v108
    v_and_b32 v107, 0x3ff, v66
    v_lshlrev_b32 v107, 2, v107
    s_waitcnt vmcnt(0)
    v_lshlrev_b32 v102, 3, v107
    v_add_u32 v102, 127744, v102
    v_lshlrev_b32 v107, 16, v112
    v_and_b32 v103, 0xffff0000, v112
    v_lshlrev_b32 v104, 16, v110
    v_mul_f32 v105, v107, v104
    ds_add_f32 v102, v105 offset:0
    v_mul_f32 v106, v103, v104
    ds_add_f32 v102, v106 offset:4
    v_and_b32 v104, 0xffff0000, v110
    v_mul_f32 v105, v107, v104
    ds_add_f32 v102, v105 offset:8
    v_mul_f32 v106, v103, v104
    ds_add_f32 v102, v106 offset:12
    v_lshlrev_b32 v104, 16, v111
    v_mul_f32 v105, v107, v104
    ds_add_f32 v102, v105 offset:16
    v_mul_f32 v106, v103, v104
    ds_add_f32 v102, v106 offset:20
    v_and_b32 v104, 0xffff0000, v111
    v_mul_f32 v105, v107, v104
    ds_add_f32 v102, v105 offset:24
    v_mul_f32 v106, v103, v104
    ds_add_f32 v102, v106 offset:28
    s_andn2_b64 exec, s[0:1], vcc
    s_branch k2_sorN14
k2_soN15:
    s_and_saveexec_b64 s[0:1], vcc
    v_lshrrev_b32 v107, 7, v70
    v_and_b32 v107, 0x1ff8, v107
    v_mul_u32_u24 v108, 1250, v71
    v_add_u32 v107, v107, v108
    buffer_load_dwordx2 v[110:111], v107, s[8:11], 0 offen
    v_cvt_f32_i32 v112, v70
    v_mul_f32 v112, 0x30002008, v112
    v_fma_f32 v108, v112, v112, -0.5
    v_cvt_pk_bf16_f32 v112, v112, v108
    v_and_b32 v107, 0x3ff, v70
    v_lshlrev_b32 v107, 2, v107
    s_waitcnt vmcnt(0)
    v_lshlrev_b32 v102, 3, v107
    v_add_u32 v102, 127744, v102
    v_lshlrev_b32 v107, 16, v112
    v_and_b32 v103, 0xffff0000, v112
    v_lshlrev_b32 v104, 16, v110
    v_mul_f32 v105, v107, v104
    ds_add_f32 v102, v105 offset:0
    v_mul_f32 v106, v103, v104
    ds_add_f32 v102, v106 offset:4
    v_and_b32 v104, 0xffff0000, v110
    v_mul_f32 v105, v107, v104
    ds_add_f32 v102, v105 offset:8
    v_mul_f32 v106, v103, v104
    ds_add_f32 v102, v106 offset:12
    v_lshlrev_b32 v104, 16, v111
    v_mul_f32 v105, v107, v104
    ds_add_f32 v102, v105 offset:16
    v_mul_f32 v106, v103, v104
    ds_add_f32 v102, v106 offset:20
    v_and_b32 v104, 0xffff0000, v111
    v_mul_f32 v105, v107, v104
    ds_add_f32 v102, v105 offset:24
    v_mul_f32 v106, v103, v104
    ds_add_f32 v102, v106 offset:28
    s_andn2_b64 exec, s[0:1], vcc
    s_branch k2_sorN15
k2_ovN0:
    s_and_saveexec_b64 s[0:1], vcc
    v_mov_b32 v107, 1698959
    v_mul_hi_u32 v107, v107, v11
    v_mul_u32_u24 v107, 2528, v107
    v_sub_u32 v107, v11, v107
    v_lshlrev_b32 v102, 3, v107
    v_add_u32 v102, 127744, v102
    v_lshlrev_b32 v107, 16, v10
    v_and_b32 v103, 0xffff0000, v10
    v_lshlrev_b32 v104, 16, v8
    v_mul_f32 v105, v107, v104
    ds_add_f32 v102, v105 offset:0
    v_mul_f32 v106, v103, v104
    ds_add_f32 v102, v106 offset:4
    v_and_b32 v104, 0xffff0000, v8
    v_mul_f32 v105, v107, v104
    ds_add_f32 v102, v105 offset:8
    v_mul_f32 v106, v103, v104
    ds_add_f32 v102, v106 offset:12
    v_lshlrev_b32 v104, 16, v9
    v_mul_f32 v105, v107, v104
    ds_add_f32 v102, v105 offset:16
    v_mul_f32 v106, v103, v104
    ds_add_f32 v102, v106 offset:20
    v_and_b32 v104, 0xffff0000, v9
    v_mul_f32 v105, v107, v104
    ds_add_f32 v102, v105 offset:24
    v_mul_f32 v106, v103, v104
    ds_add_f32 v102, v106 offset:28
    s_andn2_b64 exec, s[0:1], vcc
    s_branch k2_ovrN0
k2_ovN1:
    s_and_saveexec_b64 s[0:1], vcc
    v_mov_b32 v107, 1698959
    v_mul_hi_u32 v107, v107, v15
    v_mul_u32_u24 v107, 2528, v107
    v_sub_u32 v107, v15, v107
    v_lshlrev_b32 v102, 3, v107
    v_add_u32 v102, 127744, v102
    v_lshlrev_b32 v107, 16, v14
    v_and_b32 v103, 0xffff0000, v14
    v_lshlrev_b32 v104, 16, v12
    v_mul_f32 v105, v107, v104
    ds_add_f32 v102, v105 offset:0
    v_mul_f32 v106, v103, v104
    ds_add_f32 v102, v106 offset:4
    v_and_b32 v104, 0xffff0000, v12
    v_mul_f32 v105, v107, v104
    ds_add_f32 v102, v105 offset:8
    v_mul_f32 v106, v103, v104
    ds_add_f32 v102, v106 offset:12
    v_lshlrev_b32 v104, 16, v13
    v_mul_f32 v105, v107, v104
    ds_add_f32 v102, v105 offset:16
    v_mul_f32 v106, v103, v104
    ds_add_f32 v102, v106 offset:20
    v_and_b32 v104, 0xffff0000, v13
    v_mul_f32 v105, v107, v104
    ds_add_f32 v102, v105 offset:24
    v_mul_f32 v106, v103, v104
    ds_add_f32 v102, v106 offset:28
    s_andn2_b64 exec, s[0:1], vcc
    s_branch k2_ovrN1
k2_ovN2:
    s_and_saveexec_b64 s[0:1], vcc
    v_mov_b32 v107, 1698959
    v_mul_hi_u32 v107, v107, v19
    v_mul_u32_u24 v107, 2528, v107
    v_sub_u32 v107, v19, v107
    v_lshlrev_b32 v102, 3, v107
    v_add_u32 v102, 127744, v102
    v_lshlrev_b32 v107, 16, v18
    v_and_b32 v103, 0xffff0000, v18
    v_lshlrev_b32 v104, 16, v16
    v_mul_f32 v105, v107, v104
    ds_add_f32 v102, v105 offset:0
    v_mul_f32 v106, v103, v104
    ds_add_f32 v102, v106 offset:4
    v_and_b32 v104, 0xffff0000, v16
    v_mul_f32 v105, v107, v104
    ds_add_f32 v102, v105 offset:8
    v_mul_f32 v106, v103, v104
    ds_add_f32 v102, v106 offset:12
    v_lshlrev_b32 v104, 16, v17
    v_mul_f32 v105, v107, v104
    ds_add_f32 v102, v105 offset:16
    v_mul_f32 v106, v103, v104
    ds_add_f32 v102, v106 offset:20
    v_and_b32 v104, 0xffff0000, v17
    v_mul_f32 v105, v107, v104
    ds_add_f32 v102, v105 offset:24
    v_mul_f32 v106, v103, v104
    ds_add_f32 v102, v106 offset:28
    s_andn2_b64 exec, s[0:1], vcc
    s_branch k2_ovrN2
k2_ovN3:
    s_and_saveexec_b64 s[0:1], vcc
    v_mov_b32 v107, 1698959
    v_mul_hi_u32 v107, v107, v23
    v_mul_u32_u24 v107, 2528, v107
    v_sub_u32 v107, v23, v107
    v_lshlrev_b32 v102, 3, v107
    v_add_u32 v102, 127744, v102
    v_lshlrev_b32 v107, 16, v22
    v_and_b32 v103, 0xffff0000, v22
    v_lshlrev_b32 v104, 16, v20
    v_mul_f32 v105, v107, v104
    ds_add_f32 v102, v105 offset:0
    v_mul_f32 v106, v103, v104
    ds_add_f32 v102, v106 offset:4
    v_and_b32 v104, 0xffff0000, v20
    v_mul_f32 v105, v107, v104
    ds_add_f32 v102, v105 offset:8
    v_mul_f32 v106, v103, v104
    ds_add_f32 v102, v106 offset:12
    v_lshlrev_b32 v104, 16, v21
    v_mul_f32 v105, v107, v104
    ds_add_f32 v102, v105 offset:16
    v_mul_f32 v106, v103, v104
    ds_add_f32 v102, v106 offset:20
    v_and_b32 v104, 0xffff0000, v21
    v_mul_f32 v105, v107, v104
    ds_add_f32 v102, v105 offset:24
    v_mul_f32 v106, v103, v104
    ds_add_f32 v102, v106 offset:28
    s_andn2_b64 exec, s[0:1], vcc
    s_branch k2_ovrN3
k2_ovN4:
    s_and_saveexec_b64 s[0:1], vcc
    v_mov_b32 v107, 1698959
    v_mul_hi_u32 v107, v107, v27
    v_mul_u32_u24 v107, 2528, v107
    v_sub_u32 v107, v27, v107
    v_lshlrev_b32 v102, 3, v107
    v_add_u32 v102, 127744, v102
    v_lshlrev_b32 v107, 16, v26
    v_and_b32 v103, 0xffff0000, v26
    v_lshlrev_b32 v104, 16, v24
    v_mul_f32 v105, v107, v104
    ds_add_f32 v102, v105 offset:0
    v_mul_f32 v106, v103, v104
    ds_add_f32 v102, v106 offset:4
    v_and_b32 v104, 0xffff0000, v24
    v_mul_f32 v105, v107, v104
    ds_add_f32 v102, v105 offset:8
    v_mul_f32 v106, v103, v104
    ds_add_f32 v102, v106 offset:12
    v_lshlrev_b32 v104, 16, v25
    v_mul_f32 v105, v107, v104
    ds_add_f32 v102, v105 offset:16
    v_mul_f32 v106, v103, v104
    ds_add_f32 v102, v106 offset:20
    v_and_b32 v104, 0xffff0000, v25
    v_mul_f32 v105, v107, v104
    ds_add_f32 v102, v105 offset:24
    v_mul_f32 v106, v103, v104
    ds_add_f32 v102, v106 offset:28
    s_andn2_b64 exec, s[0:1], vcc
    s_branch k2_ovrN4
k2_ovN5:
    s_and_saveexec_b64 s[0:1], vcc
    v_mov_b32 v107, 1698959
    v_mul_hi_u32 v107, v107, v31
    v_mul_u32_u24 v107, 2528, v107
    v_sub_u32 v107, v31, v107
    v_lshlrev_b32 v102, 3, v107
    v_add_u32 v102, 127744, v102
    v_lshlrev_b32 v107, 16, v30
    v_and_b32 v103, 0xffff0000, v30
    v_lshlrev_b32 v104, 16, v28
    v_mul_f32 v105, v107, v104
    ds_add_f32 v102, v105 offset:0
    v_mul_f32 v106, v103, v104
    ds_add_f32 v102, v106 offset:4
    v_and_b32 v104, 0xffff0000, v28
    v_mul_f32 v105, v107, v104
    ds_add_f32 v102, v105 offset:8
    v_mul_f32 v106, v103, v104
    ds_add_f32 v102, v106 offset:12
    v_lshlrev_b32 v104, 16, v29
    v_mul_f32 v105, v107, v104
    ds_add_f32 v102, v105 offset:16
    v_mul_f32 v106, v103, v104
    ds_add_f32 v102, v106 offset:20
    v_and_b32 v104, 0xffff0000, v29
    v_mul_f32 v105, v107, v104
    ds_add_f32 v102, v105 offset:24
    v_mul_f32 v106, v103, v104
    ds_add_f32 v102, v106 offset:28
    s_andn2_b64 exec, s[0:1], vcc
    s_branch k2_ovrN5
k2_ovN6:
    s_and_saveexec_b64 s[0:1], vcc
    v_mov_b32 v107, 1698959
    v_mul_hi_u32 v107, v107, v35
    v_mul_u32_u24 v107, 2528, v107
    v_sub_u32 v107, v35, v107
    v_lshlrev_b32 v102, 3, v107
    v_add_u32 v102, 127744, v102
    v_lshlrev_b32 v107, 16, v34
    v_and_b32 v103, 0xffff0000, v34
    v_lshlrev_b32 v104, 16, v32
    v_mul_f32 v105, v107, v104
    ds_add_f32 v102, v105 offset:0
    v_mul_f32 v106, v103, v104
    ds_add_f32 v102, v106 offset:4
    v_and_b32 v104, 0xffff0000, v32
    v_mul_f32 v105, v107, v104
    ds_add_f32 v102, v105 offset:8
    v_mul_f32 v106, v103, v104
    ds_add_f32 v102, v106 offset:12
    v_lshlrev_b32 v104, 16, v33
    v_mul_f32 v105, v107, v104
    ds_add_f32 v102, v105 offset:16
    v_mul_f32 v106, v103, v104
    ds_add_f32 v102, v106 offset:20
    v_and_b32 v104, 0xffff0000, v33
    v_mul_f32 v105, v107, v104
    ds_add_f32 v102, v105 offset:24
    v_mul_f32 v106, v103, v104
    ds_add_f32 v102, v106 offset:28
    s_andn2_b64 exec, s[0:1], vcc
    s_branch k2_ovrN6
k2_ovN7:
    s_and_saveexec_b64 s[0:1], vcc
    v_mov_b32 v107, 1698959
    v_mul_hi_u32 v107, v107, v39
    v_mul_u32_u24 v107, 2528, v107
    v_sub_u32 v107, v39, v107
    v_lshlrev_b32 v102, 3, v107
    v_add_u32 v102, 127744, v102
    v_lshlrev_b32 v107, 16, v38
    v_and_b32 v103, 0xffff0000, v38
    v_lshlrev_b32 v104, 16, v36
    v_mul_f32 v105, v107, v104
    ds_add_f32 v102, v105 offset:0
    v_mul_f32 v106, v103, v104
    ds_add_f32 v102, v106 offset:4
    v_and_b32 v104, 0xffff0000, v36
    v_mul_f32 v105, v107, v104
    ds_add_f32 v102, v105 offset:8
    v_mul_f32 v106, v103, v104
    ds_add_f32 v102, v106 offset:12
    v_lshlrev_b32 v104, 16, v37
    v_mul_f32 v105, v107, v104
    ds_add_f32 v102, v105 offset:16
    v_mul_f32 v106, v103, v104
    ds_add_f32 v102, v106 offset:20
    v_and_b32 v104, 0xffff0000, v37
    v_mul_f32 v105, v107, v104
    ds_add_f32 v102, v105 offset:24
    v_mul_f32 v106, v103, v104
    ds_add_f32 v102, v106 offset:28
    s_andn2_b64 exec, s[0:1], vcc
    s_branch k2_ovrN7
k2_ovN8:
    s_and_saveexec_b64 s[0:1], vcc
    v_mov_b32 v107, 1698959
    v_mul_hi_u32 v107, v107, v43
    v_mul_u32_u24 v107, 2528, v107
    v_sub_u32 v107, v43, v107
    v_lshlrev_b32 v102, 3, v107
    v_add_u32 v102, 127744, v102
    v_lshlrev_b32 v107, 16, v42
    v_and_b32 v103, 0xffff0000, v42
    v_lshlrev_b32 v104, 16, v40
    v_mul_f32 v105, v107, v104
    ds_add_f32 v102, v105 offset:0
    v_mul_f32 v106, v103, v104
    ds_add_f32 v102, v106 offset:4
    v_and_b32 v104, 0xffff0000, v40
    v_mul_f32 v105, v107, v104
    ds_add_f32 v102, v105 offset:8
    v_mul_f32 v106, v103, v104
    ds_add_f32 v102, v106 offset:12
    v_lshlrev_b32 v104, 16, v41
    v_mul_f32 v105, v107, v104
    ds_add_f32 v102, v105 offset:16
    v_mul_f32 v106, v103, v104
    ds_add_f32 v102, v106 offset:20
    v_and_b32 v104, 0xffff0000, v41
    v_mul_f32 v105, v107, v104
    ds_add_f32 v102, v105 offset:24
    v_mul_f32 v106, v103, v104
    ds_add_f32 v102, v106 offset:28
    s_andn2_b64 exec, s[0:1], vcc
    s_branch k2_ovrN8
k2_ovN9:
    s_and_saveexec_b64 s[0:1], vcc
    v_mov_b32 v107, 1698959
    v_mul_hi_u32 v107, v107, v47
    v_mul_u32_u24 v107, 2528, v107
    v_sub_u32 v107, v47, v107
    v_lshlrev_b32 v102, 3, v107
    v_add_u32 v102, 127744, v102
    v_lshlrev_b32 v107, 16, v46
    v_and_b32 v103, 0xffff0000, v46
    v_lshlrev_b32 v104, 16, v44
    v_mul_f32 v105, v107, v104
    ds_add_f32 v102, v105 offset:0
    v_mul_f32 v106, v103, v104
    ds_add_f32 v102, v106 offset:4
    v_and_b32 v104, 0xffff0000, v44
    v_mul_f32 v105, v107, v104
    ds_add_f32 v102, v105 offset:8
    v_mul_f32 v106, v103, v104
    ds_add_f32 v102, v106 offset:12
    v_lshlrev_b32 v104, 16, v45
    v_mul_f32 v105, v107, v104
    ds_add_f32 v102, v105 offset:16
    v_mul_f32 v106, v103, v104
    ds_add_f32 v102, v106 offset:20
    v_and_b32 v104, 0xffff0000, v45
    v_mul_f32 v105, v107, v104
    ds_add_f32 v102, v105 offset:24
    v_mul_f32 v106, v103, v104
    ds_add_f32 v102, v106 offset:28
    s_andn2_b64 exec, s[0:1], vcc
    s_branch k2_ovrN9
k2_ovN10:
    s_and_saveexec_b64 s[0:1], vcc
    v_mov_b32 v107, 1698959
    v_mul_hi_u32 v107, v107, v51
    v_mul_u32_u24 v107, 2528, v107
    v_sub_u32 v107, v51, v107
    v_lshlrev_b32 v102, 3, v107
    v_add_u32 v102, 127744, v102
    v_lshlrev_b32 v107, 16, v50
    v_and_b32 v103, 0xffff0000, v50
    v_lshlrev_b32 v104, 16, v48
    v_mul_f32 v105, v107, v104
    ds_add_f32 v102, v105 offset:0
    v_mul_f32 v106, v103, v104
    ds_add_f32 v102, v106 offset:4
    v_and_b32 v104, 0xffff0000, v48
    v_mul_f32 v105, v107, v104
    ds_add_f32 v102, v105 offset:8
    v_mul_f32 v106, v103, v104
    ds_add_f32 v102, v106 offset:12
    v_lshlrev_b32 v104, 16, v49
    v_mul_f32 v105, v107, v104
    ds_add_f32 v102, v105 offset:16
    v_mul_f32 v106, v103, v104
    ds_add_f32 v102, v106 offset:20
    v_and_b32 v104, 0xffff0000, v49
    v_mul_f32 v105, v107, v104
    ds_add_f32 v102, v105 offset:24
    v_mul_f32 v106, v103, v104
    ds_add_f32 v102, v106 offset:28
    s_andn2_b64 exec, s[0:1], vcc
    s_branch k2_ovrN10
k2_ovN11:
    s_and_saveexec_b64 s[0:1], vcc
    v_mov_b32 v107, 1698959
    v_mul_hi_u32 v107, v107, v55
    v_mul_u32_u24 v107, 2528, v107
    v_sub_u32 v107, v55, v107
    v_lshlrev_b32 v102, 3, v107
    v_add_u32 v102, 127744, v102
    v_lshlrev_b32 v107, 16, v54
    v_and_b32 v103, 0xffff0000, v54
    v_lshlrev_b32 v104, 16, v52
    v_mul_f32 v105, v107, v104
    ds_add_f32 v102, v105 offset:0
    v_mul_f32 v106, v103, v104
    ds_add_f32 v102, v106 offset:4
    v_and_b32 v104, 0xffff0000, v52
    v_mul_f32 v105, v107, v104
    ds_add_f32 v102, v105 offset:8
    v_mul_f32 v106, v103, v104
    ds_add_f32 v102, v106 offset:12
    v_lshlrev_b32 v104, 16, v53
    v_mul_f32 v105, v107, v104
    ds_add_f32 v102, v105 offset:16
    v_mul_f32 v106, v103, v104
    ds_add_f32 v102, v106 offset:20
    v_and_b32 v104, 0xffff0000, v53
    v_mul_f32 v105, v107, v104
    ds_add_f32 v102, v105 offset:24
    v_mul_f32 v106, v103, v104
    ds_add_f32 v102, v106 offset:28
    s_andn2_b64 exec, s[0:1], vcc
    s_branch k2_ovrN11
k2_ovN12:
    s_and_saveexec_b64 s[0:1], vcc
    v_mov_b32 v107, 1698959
    v_mul_hi_u32 v107, v107, v59
    v_mul_u32_u24 v107, 2528, v107
    v_sub_u32 v107, v59, v107
    v_lshlrev_b32 v102, 3, v107
    v_add_u32 v102, 127744, v102
    v_lshlrev_b32 v107, 16, v58
    v_and_b32 v103, 0xffff0000, v58
    v_lshlrev_b32 v104, 16, v56
    v_mul_f32 v105, v107, v104
    ds_add_f32 v102, v105 offset:0
    v_mul_f32 v106, v103, v104
    ds_add_f32 v102, v106 offset:4
    v_and_b32 v104, 0xffff0000, v56
    v_mul_f32 v105, v107, v104
    ds_add_f32 v102, v105 offset:8
    v_mul_f32 v106, v103, v104
    ds_add_f32 v102, v106 offset:12
    v_lshlrev_b32 v104, 16, v57
    v_mul_f32 v105, v107, v104
    ds_add_f32 v102, v105 offset:16
    v_mul_f32 v106, v103, v104
    ds_add_f32 v102, v106 offset:20
    v_and_b32 v104, 0xffff0000, v57
    v_mul_f32 v105, v107, v104
    ds_add_f32 v102, v105 offset:24
    v_mul_f32 v106, v103, v104
    ds_add_f32 v102, v106 offset:28
    s_andn2_b64 exec, s[0:1], vcc
    s_branch k2_ovrN12
k2_ovN13:
    s_and_saveexec_b64 s[0:1], vcc
    v_mov_b32 v107, 1698959
    v_mul_hi_u32 v107, v107, v63
    v_mul_u32_u24 v107, 2528, v107
    v_sub_u32 v107, v63, v107
    v_lshlrev_b32 v102, 3, v107
    v_add_u32 v102, 127744, v102
    v_lshlrev_b32 v107, 16, v62
    v_and_b32 v103, 0xffff0000, v62
    v_lshlrev_b32 v104, 16, v60
    v_mul_f32 v105, v107, v104
    ds_add_f32 v102, v105 offset:0
    v_mul_f32 v106, v103, v104
    ds_add_f32 v102, v106 offset:4
    v_and_b32 v104, 0xffff0000, v60
    v_mul_f32 v105, v107, v104
    ds_add_f32 v102, v105 offset:8
    v_mul_f32 v106, v103, v104
    ds_add_f32 v102, v106 offset:12
    v_lshlrev_b32 v104, 16, v61
    v_mul_f32 v105, v107, v104
    ds_add_f32 v102, v105 offset:16
    v_mul_f32 v106, v103, v104
    ds_add_f32 v102, v106 offset:20
    v_and_b32 v104, 0xffff0000, v61
    v_mul_f32 v105, v107, v104
    ds_add_f32 v102, v105 offset:24
    v_mul_f32 v106, v103, v104
    ds_add_f32 v102, v106 offset:28
    s_andn2_b64 exec, s[0:1], vcc
    s_branch k2_ovrN13
k2_ovN14:
    s_and_saveexec_b64 s[0:1], vcc
    v_mov_b32 v107, 1698959
    v_mul_hi_u32 v107, v107, v67
    v_mul_u32_u24 v107, 2528, v107
    v_sub_u32 v107, v67, v107
    v_lshlrev_b32 v102, 3, v107
    v_add_u32 v102, 127744, v102
    v_lshlrev_b32 v107, 16, v66
    v_and_b32 v103, 0xffff0000, v66
    v_lshlrev_b32 v104, 16, v64
    v_mul_f32 v105, v107, v104
    ds_add_f32 v102, v105 offset:0
    v_mul_f32 v106, v103, v104
    ds_add_f32 v102, v106 offset:4
    v_and_b32 v104, 0xffff0000, v64
    v_mul_f32 v105, v107, v104
    ds_add_f32 v102, v105 offset:8
    v_mul_f32 v106, v103, v104
    ds_add_f32 v102, v106 offset:12
    v_lshlrev_b32 v104, 16, v65
    v_mul_f32 v105, v107, v104
    ds_add_f32 v102, v105 offset:16
    v_mul_f32 v106, v103, v104
    ds_add_f32 v102, v106 offset:20
    v_and_b32 v104, 0xffff0000, v65
    v_mul_f32 v105, v107, v104
    ds_add_f32 v102, v105 offset:24
    v_mul_f32 v106, v103, v104
    ds_add_f32 v102, v106 offset:28
    s_andn2_b64 exec, s[0:1], vcc
    s_branch k2_ovrN14
k2_ovN15:
    s_and_saveexec_b64 s[0:1], vcc
    v_mov_b32 v107, 1698959
    v_mul_hi_u32 v107, v107, v71
    v_mul_u32_u24 v107, 2528, v107
    v_sub_u32 v107, v71, v107
    v_lshlrev_b32 v102, 3, v107
    v_add_u32 v102, 127744, v102
    v_lshlrev_b32 v107, 16, v70
    v_and_b32 v103, 0xffff0000, v70
    v_lshlrev_b32 v104, 16, v68
    v_mul_f32 v105, v107, v104
    ds_add_f32 v102, v105 offset:0
    v_mul_f32 v106, v103, v104
    ds_add_f32 v102, v106 offset:4
    v_and_b32 v104, 0xffff0000, v68
    v_mul_f32 v105, v107, v104
    ds_add_f32 v102, v105 offset:8
    v_mul_f32 v106, v103, v104
    ds_add_f32 v102, v106 offset:12
    v_lshlrev_b32 v104, 16, v69
    v_mul_f32 v105, v107, v104
    ds_add_f32 v102, v105 offset:16
    v_mul_f32 v106, v103, v104
    ds_add_f32 v102, v106 offset:20
    v_and_b32 v104, 0xffff0000, v69
    v_mul_f32 v105, v107, v104
    ds_add_f32 v102, v105 offset:24
    v_mul_f32 v106, v103, v104
    ds_add_f32 v102, v106 offset:28
    s_andn2_b64 exec, s[0:1], vcc
    s_branch k2_ovrN15
k_last:
    s_endpgm
.section .rodata,"a"
.p2align 6
.amdhsa_kernel standalone__molecular_angular_gemnet__graph_kernel
  .amdhsa_next_free_vgpr 120
  .amdhsa_next_free_sgpr 102
  .amdhsa_accum_offset 120
  .amdhsa_group_segment_fixed_size 0
  .amdhsa_kernarg_size 112
  .amdhsa_user_sgpr_count 2
  .amdhsa_user_sgpr_kernarg_segment_ptr 1
  .amdhsa_system_sgpr_workgroup_id_x 1
.end_amdhsa_kernel
```
